```python
import torch

def _softmax(x, axis=-1):
    return torch.softmax(x, dim=axis)
def _gelu(x):
    return torch.nn.functional.gelu(x, approximate="tanh")
def _silu(x):
    return torch.nn.functional.silu(x)
def _sigmoid(x):
    return torch.sigmoid(x)
def _layernorm(x, axis=-1, eps=1e-5):
    m = x.mean(dim=axis, keepdim=True)
    v = x.var(dim=axis, keepdim=True, unbiased=False)
    return (x - m) / torch.sqrt(v + eps)
def _scatter_add(tgt, idx, src, axis=0):
    return tgt.clone().index_add_(axis, idx, src)
def _segment_sum(src, seg, n):
    out = torch.zeros((n,) + src.shape[1:], dtype=src.dtype)
    return out.index_add_(0, seg, src)
def _pad(x, pw):
    flat = tuple(v for pair in reversed(pw) for v in pair)
    return torch.nn.functional.pad(x, flat)

kernel_name = 'standalone__gqa_block_cached__sampling'

def setup_inputs():

    _w = (lambda a: (lambda t: t.to(torch.bfloat16) if t.is_floating_point() else t)(torch.as_tensor(a)))
    B, Sq, D = 32, 4, 1024
    Hq, Hkv, Sk, Dh = 32, 4, 2048, 128
    assert Hq % Hkv == 0, (Hq, Hkv)
    return {
        "x": _w((lambda *s: torch.randn(*s, dtype=torch.bfloat16) * 0.8)(B, Sq, D)),
        "k_cache": _w((lambda *s: torch.randn(*s, dtype=torch.bfloat16) * 0.8)(B, Hkv, Sk, Dh)),
        "v_cache": _w((lambda *s: torch.randn(*s, dtype=torch.bfloat16) * 0.05)(B, Hkv, Sk, Dh)),
        "wq": _w((lambda *s: torch.randn(*s, dtype=torch.bfloat16) * 0.8)(D, Hq * Dh) * (D ** -0.5)),
        "wo": _w((lambda *s: torch.randn(*s, dtype=torch.bfloat16) * 0.05)(Hq * Dh, D) * ((Hq * Dh) ** -0.5)),
    }

def reference(x, k_cache, v_cache, wq, wo):
    B, Sq, D = x.shape
    Hq, Dh = 32, 128
    Hkv = k_cache.shape[1]
    rep = Hq // Hkv
    q = (lambda x, *d: x.permute(*d))((x @ wq).reshape(B, Sq, Hq, Dh), 0, 2, 1, 3)
    k = (lambda x, n, axis: torch.repeat_interleave(x, n, dim=axis))(k_cache, rep, axis=1)
    v = (lambda x, n, axis: torch.repeat_interleave(x, n, dim=axis))(v_cache, rep, axis=1)
    scores = torch.einsum("bhqd,bhkd->bhqk", q, k) * (Dh ** -0.5)
    p = _softmax(scores, axis=-1)
    o = torch.einsum("bhqk,bhkd->bhqd", p, v)
    return (lambda x, *d: x.permute(*d))(o, 0, 2, 1, 3).reshape(B, Sq, Hq * Dh) @ wo
```

```asm
; @launch grid=(256,1,1) block=(512,1,1) lds=155904
.amdgcn_target "amdgcn-amd-amdhsa--gfx950"
.text
.globl standalone__gqa_block_cached__sampling_kernel
.p2align 8
.type standalone__gqa_block_cached__sampling_kernel,@function
standalone__gqa_block_cached__sampling_kernel:
    s_cmp_ge_u32 s2, 256
    s_cbranch_scc1 L_end
    s_load_dwordx16 s[4:19], s[0:1], 0
    v_lshrrev_b32 v12, 6, v0
    s_nop 0
    v_readfirstlane_b32 s52, v12
    v_and_b32 v16, 15, v0
    v_bfe_u32 v17, v0, 4, 2
    v_and_b32 v1, 63, v0
    v_lshlrev_b32 v1, 4, v1
    v_bfe_u32 v12, v0, 2, 1
    v_and_b32 v13, 3, v0
    v_lshl_add_u32 v2, v12, 3, v13
    v_lshlrev_b32 v2, 8, v2
    v_bfe_u32 v12, v0, 3, 1
    v_lshl_add_u32 v2, v12, 6, v2
    v_lshl_add_u32 v2, v17, 4, v2
    s_and_b32 s60, s2, 7
    s_lshr_b32 s47, s2, 3
    s_and_b32 s56, s47, 1
    s_lshr_b32 s55, s47, 1
    s_lshl_b32 s55, s55, 3
    s_add_u32 s55, s55, s60
    s_lshl_b32 s57, s55, 1
    s_add_u32 s57, s57, s56
    s_lshl_b32 s57, s57, 18
    s_lshl_b32 s100, s52, 13
    s_add_u32 s100, s57, s100
    s_and_b32 s53, s52, 3
    s_lshr_b32 s54, s52, 2
    v_bfe_u32 v14, v0, 6, 1
    v_bfe_u32 v12, v0, 4, 1
    v_lshl_add_u32 v12, v14, 1, v12
    v_lshlrev_b32 v12, 1, v12
    v_and_b32 v15, 7, v0
    v_xor_b32 v12, v12, v15
    v_lshlrev_b32 v12, 4, v12
    v_bfe_u32 v14, v0, 3, 3
    v_lshl_add_u32 v4, v14, 13, v12
    v_lshl_add_u32 v3, v14, 8, v12
    v_bfe_u32 v12, v0, 4, 3
    v_xor_b32 v12, v12, v15
    v_lshlrev_b32 v12, 4, v12
    v_lshl_add_u32 v36, v14, 11, v12
    s_waitcnt lgkmcnt(0)
    s_mov_b32 s24, s6
    s_and_b32 s25, s7, 0xffff
    s_mov_b32 s26, 0x4000000
    s_mov_b32 s27, 0x20000
    s_add_u32 s101, s100, 0
    buffer_load_dwordx4 v[128:131], v2, s[24:27], s101 offen offset:0 nt
    s_add_u32 s101, s100, 4096
    buffer_load_dwordx4 v[136:139], v2, s[24:27], s101 offen offset:0 nt
    s_add_u32 s101, s100, 0
    buffer_load_dwordx4 v[132:135], v2, s[24:27], s101 offen offset:128 nt
    s_mov_b32 s48, s18
    s_and_b32 s49, s19, 0xffff
    s_mov_b32 s50, 0x10000000
    s_mov_b32 s51, 0x20000
    s_load_dword s58, s[18:19], 0
    s_mov_b32 s20, s4
    s_and_b32 s21, s5, 0xffff
    s_mov_b32 s22, 0x40000
    s_mov_b32 s23, 0x20000
    s_mov_b32 s32, s10
    s_and_b32 s33, s11, 0xffff
    s_mov_b32 s34, 0x800000
    s_mov_b32 s35, 0x20000
    s_mov_b32 s28, s8
    s_and_b32 s29, s9, 0xffff
    s_mov_b32 s30, 0x4000000
    s_mov_b32 s31, 0x20000
    s_mov_b32 s36, s12
    s_and_b32 s37, s13, 0xffff
    s_mov_b32 s38, 0x800000
    s_mov_b32 s39, 0x20000
    s_mov_b32 s40, s14
    s_and_b32 s41, s15, 0xffff
    s_mov_b32 s42, 0x40000
    s_mov_b32 s43, 0x20000
    s_mov_b32 s4, s2
    s_mov_b32 s17, s60
    s_add_u32 s5, s17, 2
    s_and_b32 s5, s5, 3
    s_lshl_b32 s5, s5, 4
    s_add_u32 s62, s47, 1
    s_and_b32 s62, s62, 15
    s_add_u32 s5, s5, s62
    s_lshr_b32 s6, s47, 4
    s_lshr_b32 s7, s17, 2
    s_lshl_b32 s8, s6, 17
    s_lshl_b32 s61, s52, 14
    s_add_u32 s8, s8, s61
    s_lshl_b32 s61, s7, 10
    s_add_u32 s8, s8, s61
    s_lshl_b32 s9, s5, 7
    s_lshl_b32 s60, s52, 16
    s_add_u32 s9, s9, s60
    s_lshl_b32 s60, s7, 22
    s_add_u32 s9, s9, s60
    s_lshl_b32 s10, s52, 10
    s_add_u32 s10, s10, 98304
    s_add_u32 m0, s10, 0
    s_add_u32 s101, s9, 0
    buffer_load_dwordx4 v4, s[32:35], s101 offen lds
    s_sub_u32 m0, s10, 98304
    s_add_u32 s101, s8, 0
    buffer_load_dwordx4 v36, s[20:23], s101 offen lds
    s_lshl_b32 s60, s47, 3
    s_add_u32 s60, s60, s52
    s_cmp_ge_u32 s60, 3
    s_cbranch_scc1 L_nopf
    s_getpc_b64 s[60:61]
    s_and_b32 s60, s60, 0xffffff80
    s_lshl_b32 s62, s52, 13
    v_lshlrev_b32 v48, 3, v1
    v_add_u32 v48, s62, v48
    v_min_u32 v48, 0x37ac, v48
    global_load_dword v49, v48, s[60:61]
L_nopf:
    v_bfe_u32 v12, v0, 2, 2
    v_lshl_add_u32 v14, v17, 3, v12
    v_lshlrev_b32 v5, 7, v14
    v_bfe_u32 v14, v0, 3, 2
    v_xor_b32 v14, s53, v14
    v_lshl_add_u32 v5, v14, 5, v5
    v_lshl_add_u32 v5, v13, 3, v5
    v_add_u32 v5, 0x18000, v5
    s_lshl_b32 s60, s54, 10
    v_add_u32 v6, s60, v1
    v_lshlrev_b32 v7, 10, v12
    v_lshl_add_u32 v7, v17, 6, v7
    v_lshl_add_u32 v7, v13, 4, v7
    v_bfe_u32 v14, v0, 5, 1
    v_lshlrev_b32 v8, 6, v14
    v_lshl_add_u32 v8, v13, 4, v8
    s_lshl_b32 s15, s55, 13
    s_lshl_b32 s60, s54, 12
    s_add_u32 s99, s15, s60
    s_lshl_b32 s60, s56, 11
    s_add_u32 s99, s99, s60
    s_lshl_b32 s60, s53, 9
    s_add_u32 s99, s99, s60
    s_add_u32 s99, s99, 3145728
    v_lshlrev_b32 v10, 8, v14
    v_lshl_add_u32 v10, v16, 4, v10
    v_lshl_add_u32 v8, v12, 15, v8
    v_bfe_u32 v14, v0, 4, 1
    v_lshl_add_u32 v8, v14, 17, v8
    s_mov_b32 s0, 0xffff
    s_mov_b32 s1, 0xffff
    s_lshl_b32 s16, s4, 3
    s_add_u32 s16, s16, s52
    s_lshl_b32 s16, s16, 10
    v_mov_b32 v44, -1
    v_mov_b32 v45, -1
    v_mov_b32 v46, -1
    v_mov_b32 v47, -1
    v_lshrrev_b32 v38, 1, v1
    s_mov_b64 exec, s[0:1]
    buffer_store_dwordx4 v[44:47], v10, s[48:51], s99 offen sc1
    s_getreg_b32 s86, hwreg(HW_REG_XCC_ID, 0, 4)
    s_mov_b64 exec, -1
    v_lshrrev_b32 v12, 1, v16
    v_xor_b32 v12, v17, v12
    v_lshlrev_b32 v12, 4, v12
    v_lshl_add_u32 v12, v16, 7, v12
    s_lshl_b32 s60, s54, 12
    v_add_u32 v32, s60, v12
    v_xor_b32 v33, 64, v32
    s_lshl_b32 s60, s52, 11
    s_add_u32 s60, s60, s57
    s_lshl_b32 s61, s56, 7
    s_add_u32 s12, s60, s61
    s_xor_b32 s11, s12, 128
    s_mov_b32 s59, 0x3e0293ee
    s_add_u32 s46, s17, 1
    s_and_b32 s46, s46, 3
    s_lshr_b32 s44, s17, 2
    s_lshl_b32 s44, s44, 3
    s_add_u32 s60, s47, 5
    s_and_b32 s60, s60, 7
    s_add_u32 s44, s44, s60
    s_lshr_b32 s45, s47, 3
    v_lshlrev_b32 v11, 3, v16
    v_add_u32 v11, 0x26000, v11
    v_mov_b32 v18, 0xff800000
    v_mov_b32 v19, 0xff800000
    ds_write_b64 v11, v[18:19]
    s_waitcnt lgkmcnt(0)
    s_add_u32 s58, s58, 0x01010101
    s_cmp_eq_u32 s54, 0
    s_cselect_b64 s[18:19], -1, 0
    s_mov_b64 vcc, 0
    s_and_b32 s60, s5, 7
    s_cmp_eq_u32 s60, 3
    s_cselect_b64 vcc, -1, vcc
    s_and_b32 s60, s44, 7
    s_cmp_eq_u32 s60, 3
    s_cselect_b64 vcc, -1, vcc
    s_waitcnt vmcnt(5)
    s_add_u32 m0, s10, 8192
    s_add_u32 s101, s9, 524288
    buffer_load_dwordx4 v4, s[32:35], s101 offen lds
    s_sub_u32 m0, s10, 90112
    s_add_u32 s101, s8, 128
    buffer_load_dwordx4 v36, s[20:23], s101 offen lds
    s_add_u32 s101, s100, 4096
    buffer_load_dwordx4 v[140:143], v2, s[24:27], s101 offen offset:128 nt
    s_barrier
    s_waitcnt vmcnt(7)
    s_add_u32 m0, s10, 16384
    s_add_u32 s101, s9, 1048576
    buffer_load_dwordx4 v4, s[32:35], s101 offen lds
    s_sub_u32 m0, s10, 81920
    s_add_u32 s101, s8, 256
    buffer_load_dwordx4 v36, s[20:23], s101 offen lds
    s_add_u32 s101, s100, 0
    buffer_load_dwordx4 v[144:147], v2, s[24:27], s101 offen offset:1024 nt
    s_barrier
    s_waitcnt vmcnt(9)
    s_add_u32 m0, s10, 24576
    s_add_u32 s101, s9, 1572864
    buffer_load_dwordx4 v4, s[32:35], s101 offen lds
    s_sub_u32 m0, s10, 73728
    s_add_u32 s101, s8, 384
    buffer_load_dwordx4 v36, s[20:23], s101 offen lds
    s_add_u32 s101, s100, 4096
    buffer_load_dwordx4 v[152:155], v2, s[24:27], s101 offen offset:1024 nt
    s_barrier
    v_mov_b32 v12, v128
    v_mov_b32 v13, v129
    v_mov_b32 v14, v130
    v_mov_b32 v15, v131
    v_mov_b32_dpp v128, v136 row_ror:8 row_mask:0xf bank_mask:0xc
    v_mov_b32_dpp v129, v137 row_ror:8 row_mask:0xf bank_mask:0xc
    v_mov_b32_dpp v130, v138 row_ror:8 row_mask:0xf bank_mask:0xc
    v_mov_b32_dpp v131, v139 row_ror:8 row_mask:0xf bank_mask:0xc
    v_mov_b32_dpp v136, v12 row_ror:8 row_mask:0xf bank_mask:0x3
    v_mov_b32_dpp v137, v13 row_ror:8 row_mask:0xf bank_mask:0x3
    v_mov_b32_dpp v138, v14 row_ror:8 row_mask:0xf bank_mask:0x3
    v_mov_b32_dpp v139, v15 row_ror:8 row_mask:0xf bank_mask:0x3
    s_waitcnt vmcnt(6)
    s_add_u32 m0, s10, 32768
    s_add_u32 s101, s9, 2097152
    buffer_load_dwordx4 v4, s[32:35], s101 offen lds
    s_sub_u32 m0, s10, 65536
    s_add_u32 s101, s8, 512
    buffer_load_dwordx4 v36, s[20:23], s101 offen lds
    s_add_u32 s101, s100, 0
    buffer_load_dwordx4 v[148:151], v2, s[24:27], s101 offen offset:1152 nt
    s_barrier
    ds_read_b64_tr_b16 v[64:65], v5 offset:0
    ds_read_b64_tr_b16 v[66:67], v5 offset:512
    ds_read_b128 v[68:71], v32 offset:0
    ds_read_b128 v[72:75], v32 offset:2048
    ds_read_b64_tr_b16 v[76:77], v5 offset:4096
    ds_read_b64_tr_b16 v[78:79], v5 offset:4608
    ds_read_b128 v[80:83], v33 offset:0
    ds_read_b128 v[84:87], v33 offset:2048
    ds_read_b64_tr_b16 v[88:89], v5 offset:8192
    ds_read_b64_tr_b16 v[90:91], v5 offset:8704
    ds_read_b128 v[92:95], v32 offset:8192
    ds_read_b128 v[96:99], v32 offset:10240
    s_waitcnt lgkmcnt(9)
    v_mfma_f32_16x16x32_bf16 v[20:23], v[64:67], v[68:71], 0
    s_waitcnt lgkmcnt(8)
    v_mfma_f32_16x16x32_bf16 v[24:27], v[64:67], v[72:75], 0
    ds_read_b64_tr_b16 v[100:101], v5 offset:12288
    ds_read_b64_tr_b16 v[102:103], v5 offset:12800
    ds_read_b128 v[104:107], v33 offset:8192
    ds_read_b128 v[108:111], v33 offset:10240
    s_waitcnt lgkmcnt(9)
    v_mfma_f32_16x16x32_bf16 v[20:23], v[76:79], v[80:83], v[20:23]
    s_waitcnt lgkmcnt(8)
    v_mfma_f32_16x16x32_bf16 v[24:27], v[76:79], v[84:87], v[24:27]
    s_waitcnt lgkmcnt(5)
    v_mfma_f32_16x16x32_bf16 v[20:23], v[88:91], v[92:95], v[20:23]
    s_waitcnt lgkmcnt(4)
    v_mfma_f32_16x16x32_bf16 v[24:27], v[88:91], v[96:99], v[24:27]
    s_waitcnt lgkmcnt(1)
    v_mfma_f32_16x16x32_bf16 v[20:23], v[100:103], v[104:107], v[20:23]
    s_waitcnt lgkmcnt(0)
    v_mfma_f32_16x16x32_bf16 v[24:27], v[100:103], v[108:111], v[24:27]
    s_waitcnt vmcnt(6)
    s_add_u32 m0, s10, 40960
    s_add_u32 s101, s9, 2621440
    buffer_load_dwordx4 v4, s[32:35], s101 offen lds
    s_sub_u32 m0, s10, 57344
    s_add_u32 s101, s8, 640
    buffer_load_dwordx4 v36, s[20:23], s101 offen lds
    s_add_u32 s101, s100, 4096
    buffer_load_dwordx4 v[156:159], v2, s[24:27], s101 offen offset:1152 nt
    s_barrier
    ds_read_b64_tr_b16 v[64:65], v5 offset:16384
    v_mov_b32 v12, v132
    v_mov_b32 v13, v133
    ds_read_b64_tr_b16 v[66:67], v5 offset:16896
    v_mov_b32 v14, v134
    v_mov_b32 v15, v135
    ds_read_b128 v[68:71], v32 offset:16384
    v_mov_b32_dpp v132, v140 row_ror:8 row_mask:0xf bank_mask:0xc
    v_mov_b32_dpp v133, v141 row_ror:8 row_mask:0xf bank_mask:0xc
    ds_read_b128 v[72:75], v32 offset:18432
    v_mov_b32_dpp v134, v142 row_ror:8 row_mask:0xf bank_mask:0xc
    v_mov_b32_dpp v135, v143 row_ror:8 row_mask:0xf bank_mask:0xc
    ds_read_b64_tr_b16 v[76:77], v5 offset:20480
    v_mov_b32_dpp v140, v12 row_ror:8 row_mask:0xf bank_mask:0x3
    v_mov_b32_dpp v141, v13 row_ror:8 row_mask:0xf bank_mask:0x3
    ds_read_b64_tr_b16 v[78:79], v5 offset:20992
    v_mov_b32_dpp v142, v14 row_ror:8 row_mask:0xf bank_mask:0x3
    v_mov_b32_dpp v143, v15 row_ror:8 row_mask:0xf bank_mask:0x3
    ds_read_b128 v[80:83], v33 offset:16384
    ds_read_b128 v[84:87], v33 offset:18432
    s_waitcnt lgkmcnt(5)
    v_mfma_f32_16x16x32_bf16 v[20:23], v[64:67], v[68:71], v[20:23]
    s_waitcnt lgkmcnt(4)
    v_mfma_f32_16x16x32_bf16 v[24:27], v[64:67], v[72:75], v[24:27]
    s_waitcnt lgkmcnt(1)
    v_mfma_f32_16x16x32_bf16 v[20:23], v[76:79], v[80:83], v[20:23]
    s_waitcnt lgkmcnt(0)
    v_mfma_f32_16x16x32_bf16 v[24:27], v[76:79], v[84:87], v[24:27]
    s_waitcnt vmcnt(6)
    s_add_u32 m0, s10, 49152
    s_add_u32 s101, s9, 3145728
    buffer_load_dwordx4 v4, s[32:35], s101 offen lds
    s_sub_u32 m0, s10, 49152
    s_add_u32 s101, s8, 768
    buffer_load_dwordx4 v36, s[20:23], s101 offen lds
    s_add_u32 s101, s100, 65536
    buffer_load_dwordx4 v[160:163], v2, s[24:27], s101 offen offset:0 nt
    s_barrier
    ds_read_b64_tr_b16 v[64:65], v5 offset:24576
    ds_read_b64_tr_b16 v[66:67], v5 offset:25088
    ds_read_b128 v[68:71], v32 offset:24576
    ds_read_b128 v[72:75], v32 offset:26624
    ds_read_b64_tr_b16 v[76:77], v5 offset:28672
    ds_read_b64_tr_b16 v[78:79], v5 offset:29184
    ds_read_b128 v[80:83], v33 offset:24576
    ds_read_b128 v[84:87], v33 offset:26624
    s_waitcnt lgkmcnt(5)
    v_mfma_f32_16x16x32_bf16 v[20:23], v[64:67], v[68:71], v[20:23]
    s_waitcnt lgkmcnt(4)
    v_mfma_f32_16x16x32_bf16 v[24:27], v[64:67], v[72:75], v[24:27]
    s_waitcnt lgkmcnt(1)
    v_mfma_f32_16x16x32_bf16 v[20:23], v[76:79], v[80:83], v[20:23]
    s_waitcnt lgkmcnt(0)
    v_mfma_f32_16x16x32_bf16 v[24:27], v[76:79], v[84:87], v[24:27]
    s_waitcnt vmcnt(6)
    s_add_u32 m0, s10, 0
    s_add_u32 s101, s9, 3670016
    buffer_load_dwordx4 v4, s[32:35], s101 offen lds
    s_sub_u32 m0, s10, 40960
    s_add_u32 s101, s8, 896
    buffer_load_dwordx4 v36, s[20:23], s101 offen lds
    s_add_u32 s101, s100, 69632
    buffer_load_dwordx4 v[168:171], v2, s[24:27], s101 offen offset:0 nt
    s_barrier
    ds_read_b64_tr_b16 v[64:65], v5 offset:32768
    v_mov_b32 v12, v144
    v_mov_b32 v13, v145
    ds_read_b64_tr_b16 v[66:67], v5 offset:33280
    v_mov_b32 v14, v146
    v_mov_b32 v15, v147
    ds_read_b128 v[68:71], v32 offset:32768
    v_mov_b32_dpp v144, v152 row_ror:8 row_mask:0xf bank_mask:0xc
    v_mov_b32_dpp v145, v153 row_ror:8 row_mask:0xf bank_mask:0xc
    ds_read_b128 v[72:75], v32 offset:34816
    v_mov_b32_dpp v146, v154 row_ror:8 row_mask:0xf bank_mask:0xc
    v_mov_b32_dpp v147, v155 row_ror:8 row_mask:0xf bank_mask:0xc
    ds_read_b64_tr_b16 v[76:77], v5 offset:36864
    v_mov_b32_dpp v152, v12 row_ror:8 row_mask:0xf bank_mask:0x3
    v_mov_b32_dpp v153, v13 row_ror:8 row_mask:0xf bank_mask:0x3
    ds_read_b64_tr_b16 v[78:79], v5 offset:37376
    v_mov_b32_dpp v154, v14 row_ror:8 row_mask:0xf bank_mask:0x3
    v_mov_b32_dpp v155, v15 row_ror:8 row_mask:0xf bank_mask:0x3
    ds_read_b128 v[80:83], v33 offset:32768
    ds_read_b128 v[84:87], v33 offset:34816
    s_waitcnt lgkmcnt(5)
    v_mfma_f32_16x16x32_bf16 v[20:23], v[64:67], v[68:71], v[20:23]
    s_waitcnt lgkmcnt(4)
    v_mfma_f32_16x16x32_bf16 v[24:27], v[64:67], v[72:75], v[24:27]
    s_waitcnt lgkmcnt(1)
    v_mfma_f32_16x16x32_bf16 v[20:23], v[76:79], v[80:83], v[20:23]
    s_waitcnt lgkmcnt(0)
    v_mfma_f32_16x16x32_bf16 v[24:27], v[76:79], v[84:87], v[24:27]
    s_waitcnt vmcnt(6)
    s_add_u32 s101, s100, 65536
    buffer_load_dwordx4 v[164:167], v2, s[24:27], s101 offen offset:128 nt
    s_barrier
    s_lshl_b32 s60, s17, 7
    s_lshl_b32 s61, s47, 2
    s_add_u32 s60, s60, s61
    s_add_u32 s60, s60, 8192
    s_cmp_eq_u32 s52, 0
    s_cselect_b32 s60, s60, 0x10000000
    s_lshl_b32 s86, s86, 28
    s_xor_b32 s86, s86, s58
    s_mov_b64 exec, 1
    v_mov_b32 v39, s86
    buffer_store_dword v39, v1, s[48:51], s60 offen
    s_mov_b64 exec, -1
    ds_read_b64_tr_b16 v[64:65], v5 offset:40960
    ds_read_b64_tr_b16 v[66:67], v5 offset:41472
    ds_read_b128 v[68:71], v32 offset:40960
    ds_read_b128 v[72:75], v32 offset:43008
    ds_read_b64_tr_b16 v[76:77], v5 offset:45056
    ds_read_b64_tr_b16 v[78:79], v5 offset:45568
    ds_read_b128 v[80:83], v33 offset:40960
    ds_read_b128 v[84:87], v33 offset:43008
    s_waitcnt lgkmcnt(5)
    v_mfma_f32_16x16x32_bf16 v[20:23], v[64:67], v[68:71], v[20:23]
    s_waitcnt lgkmcnt(4)
    v_mfma_f32_16x16x32_bf16 v[24:27], v[64:67], v[72:75], v[24:27]
    s_waitcnt lgkmcnt(1)
    v_mfma_f32_16x16x32_bf16 v[20:23], v[76:79], v[80:83], v[20:23]
    s_waitcnt lgkmcnt(0)
    v_mfma_f32_16x16x32_bf16 v[24:27], v[76:79], v[84:87], v[24:27]
    s_waitcnt vmcnt(5)
    s_add_u32 s101, s100, 69632
    buffer_load_dwordx4 v[172:175], v2, s[24:27], s101 offen offset:128 nt
    s_barrier
    ds_read_b64_tr_b16 v[64:65], v5 offset:49152
    v_mov_b32 v12, v148
    v_mov_b32 v13, v149
    ds_read_b64_tr_b16 v[66:67], v5 offset:49664
    v_mov_b32 v14, v150
    v_mov_b32 v15, v151
    ds_read_b128 v[68:71], v32 offset:49152
    v_mov_b32_dpp v148, v156 row_ror:8 row_mask:0xf bank_mask:0xc
    v_mov_b32_dpp v149, v157 row_ror:8 row_mask:0xf bank_mask:0xc
    ds_read_b128 v[72:75], v32 offset:51200
    v_mov_b32_dpp v150, v158 row_ror:8 row_mask:0xf bank_mask:0xc
    v_mov_b32_dpp v151, v159 row_ror:8 row_mask:0xf bank_mask:0xc
    ds_read_b64_tr_b16 v[76:77], v5 offset:53248
    v_mov_b32_dpp v156, v12 row_ror:8 row_mask:0xf bank_mask:0x3
    v_mov_b32_dpp v157, v13 row_ror:8 row_mask:0xf bank_mask:0x3
    ds_read_b64_tr_b16 v[78:79], v5 offset:53760
    v_mov_b32_dpp v158, v14 row_ror:8 row_mask:0xf bank_mask:0x3
    v_mov_b32_dpp v159, v15 row_ror:8 row_mask:0xf bank_mask:0x3
    ds_read_b128 v[80:83], v33 offset:49152
    ds_read_b128 v[84:87], v33 offset:51200
    s_waitcnt lgkmcnt(5)
    v_mfma_f32_16x16x32_bf16 v[20:23], v[64:67], v[68:71], v[20:23]
    s_waitcnt lgkmcnt(4)
    v_mfma_f32_16x16x32_bf16 v[24:27], v[64:67], v[72:75], v[24:27]
    s_waitcnt lgkmcnt(1)
    v_mfma_f32_16x16x32_bf16 v[20:23], v[76:79], v[80:83], v[20:23]
    s_waitcnt lgkmcnt(0)
    v_mfma_f32_16x16x32_bf16 v[24:27], v[76:79], v[84:87], v[24:27]
    s_lshl_b32 s13, s54, 9
    s_and_b32 s60, s52, 1
    s_lshl_b32 s60, s60, 8
    s_add_u32 s13, s13, s60
    s_bfe_u32 s60, s52, 0x10001
    s_lshl_b32 s60, s60, 5
    s_add_u32 s13, s13, s60
    s_lshl_b32 s60, s44, 7
    s_lshl_b32 s61, s46, 21
    s_add_u32 s60, s60, s61
    s_mov_b32 s89, 2048
    s_mul_i32 s13, s13, s89
    s_add_u32 s13, s13, s60
    v_bfe_u32 v12, v0, 5, 1
    v_bfe_u32 v13, v0, 3, 2
    v_lshl_add_u32 v12, v12, 7, v13
    v_mul_lo_u32 v9, v12, s89
    v_lshlrev_b32 v12, 1, v17
    v_and_b32 v13, 7, v0
    v_xor_b32 v12, v12, v13
    v_lshl_add_u32 v9, v12, 4, v9
    v_bfe_u32 v12, v0, 2, 4
    v_lshlrev_b32 v120, 7, v12
    v_bfe_u32 v12, v0, 3, 2
    v_lshl_add_u32 v120, v12, 5, v120
    v_and_b32 v12, 3, v0
    v_lshl_add_u32 v120, v12, 3, v120
    s_lshl_b32 s60, s53, 11
    s_add_u32 s60, s60, 32768
    v_add_u32 v120, s60, v120
    v_xor_b32 v121, 32, v120
    v_xor_b32 v122, 64, v120
    v_xor_b32 v123, 96, v120
    s_waitcnt vmcnt(3)
    s_add_u32 s101, s100, 65536
    buffer_load_dwordx4 v[176:179], v2, s[24:27], s101 offen offset:1024 nt
    s_barrier
    ds_read_b64_tr_b16 v[64:65], v5 offset:0
    s_lshl_b32 s14, s7, 20
    s_lshl_b32 s61, s6, 19
    ds_read_b64_tr_b16 v[66:67], v5 offset:512
    s_add_u32 s14, s14, s61
    s_lshl_b32 s61, s54, 18
    ds_read_b128 v[68:71], v32 offset:57344
    s_add_u32 s14, s14, s61
    s_lshl_b32 s61, s5, 9
    ds_read_b128 v[72:75], v32 offset:59392
    s_add_u32 s14, s14, s61
    s_lshl_b32 s61, s53, 7
    ds_read_b64_tr_b16 v[76:77], v5 offset:4096
    s_add_u32 s14, s14, s61
    s_add_u32 s14, s14, 1048576
    ds_read_b64_tr_b16 v[78:79], v5 offset:4608
    ds_read_b128 v[80:83], v33 offset:57344
    ds_read_b128 v[84:87], v33 offset:59392
    s_waitcnt lgkmcnt(5)
    v_mfma_f32_16x16x32_bf16 v[20:23], v[64:67], v[68:71], v[20:23]
    s_waitcnt lgkmcnt(4)
    v_mfma_f32_16x16x32_bf16 v[24:27], v[64:67], v[72:75], v[24:27]
    s_waitcnt lgkmcnt(1)
    v_mfma_f32_16x16x32_bf16 v[20:23], v[76:79], v[80:83], v[20:23]
    s_waitcnt lgkmcnt(0)
    v_mfma_f32_16x16x32_bf16 v[24:27], v[76:79], v[84:87], v[24:27]
    s_nop 5
    v_cvt_pk_bf16_f32 v112, v20, v21
    v_cvt_pk_bf16_f32 v113, v22, v23
    v_cvt_pk_bf16_f32 v114, v24, v25
    v_cvt_pk_bf16_f32 v115, v26, v27
    s_nop 0
    v_permlane16_swap_b32 v112, v114
    v_permlane16_swap_b32 v113, v115
    buffer_store_dwordx4 v[112:115], v8, s[48:51], s14 offen sc1
    s_cbranch_vccnz L_pf13
    s_waitcnt vmcnt(4)
L_pf13:
    s_add_u32 s101, s100, 69632
    buffer_load_dwordx4 v[184:187], v2, s[24:27], s101 offen offset:1024 nt
    s_barrier
    v_mov_b32 v12, v160
    v_mov_b32 v13, v161
    v_mov_b32 v14, v162
    v_mov_b32 v15, v163
    v_mov_b32_dpp v160, v168 row_ror:8 row_mask:0xf bank_mask:0xc
    v_mov_b32_dpp v161, v169 row_ror:8 row_mask:0xf bank_mask:0xc
    v_mov_b32_dpp v162, v170 row_ror:8 row_mask:0xf bank_mask:0xc
    v_mov_b32_dpp v163, v171 row_ror:8 row_mask:0xf bank_mask:0xc
    v_mov_b32_dpp v168, v12 row_ror:8 row_mask:0xf bank_mask:0x3
    v_mov_b32_dpp v169, v13 row_ror:8 row_mask:0xf bank_mask:0x3
    v_mov_b32_dpp v170, v14 row_ror:8 row_mask:0xf bank_mask:0x3
    v_mov_b32_dpp v171, v15 row_ror:8 row_mask:0xf bank_mask:0x3
    s_waitcnt vmcnt(5)
    s_cbranch_vccnz L_pf14
    s_waitcnt vmcnt(3)
L_pf14:
    s_sub_u32 m0, s10, 65536
    s_mul_i32 s101, s89, 0
    s_add_u32 s101, s101, s13
    buffer_load_dwordx4 v9, s[36:39], s101 offen sc1 lds
    s_add_u32 s101, s100, 65536
    buffer_load_dwordx4 v[180:183], v2, s[24:27], s101 offen offset:1152 nt
    s_barrier
    s_waitcnt vmcnt(5)
    s_cbranch_vccnz L_pf15
    s_waitcnt vmcnt(4)
L_pf15:
    s_add_u32 s101, s100, 69632
    buffer_load_dwordx4 v[188:191], v2, s[24:27], s101 offen offset:1152 nt
    s_barrier
    v_mov_b32 v12, v164
    v_mov_b32 v13, v165
    v_mov_b32 v14, v166
    v_mov_b32 v15, v167
    v_mov_b32_dpp v164, v172 row_ror:8 row_mask:0xf bank_mask:0xc
    v_mov_b32_dpp v165, v173 row_ror:8 row_mask:0xf bank_mask:0xc
    v_mov_b32_dpp v166, v174 row_ror:8 row_mask:0xf bank_mask:0xc
    v_mov_b32_dpp v167, v175 row_ror:8 row_mask:0xf bank_mask:0xc
    v_mov_b32_dpp v172, v12 row_ror:8 row_mask:0xf bank_mask:0x3
    v_mov_b32_dpp v173, v13 row_ror:8 row_mask:0xf bank_mask:0x3
    v_mov_b32_dpp v174, v14 row_ror:8 row_mask:0xf bank_mask:0x3
    v_mov_b32_dpp v175, v15 row_ror:8 row_mask:0xf bank_mask:0x3
    s_waitcnt vmcnt(5)
    s_cbranch_vccnz L_pf16
    s_waitcnt vmcnt(3)
L_pf16:
    s_add_u32 s101, s100, 131072
    buffer_load_dwordx4 v[192:195], v2, s[24:27], s101 offen offset:0 nt
    s_waitcnt vmcnt(5)
    s_barrier
    s_cmp_lg_u32 s52, 0
    s_cbranch_scc1 L_ow_flag
    s_lshr_b32 s60, s5, 4
    s_lshl_b32 s60, s60, 1
    s_add_u32 s60, s60, s6
    s_lshl_b32 s60, s60, 4
    s_and_b32 s61, s5, 15
    s_add_u32 s60, s60, s61
    s_lshl_b32 s60, s60, 1
    s_add_u32 s60, s60, s7
    s_lshl_b32 s60, s60, 2
    s_mov_b64 exec, 1
    v_mov_b32 v12, s58
    buffer_store_dword v12, v1, s[48:51], s60 offen offset:1024 sc1
    s_mov_b64 exec, -1
L_ow_flag:
    s_waitcnt vmcnt(4)
    s_cbranch_vccnz L_pf17
    s_waitcnt vmcnt(2)
L_pf17:
    s_sub_u32 m0, s10, 57344
    s_mul_i32 s101, s89, 4
    s_add_u32 s101, s101, s13
    buffer_load_dwordx4 v9, s[36:39], s101 offen sc1 lds
    s_add_u32 s101, s100, 135168
    buffer_load_dwordx4 v[200:203], v2, s[24:27], s101 offen offset:0 nt
    s_barrier
    v_mov_b32 v12, v176
    v_mov_b32 v13, v177
    v_mov_b32 v14, v178
    v_mov_b32 v15, v179
    v_mov_b32_dpp v176, v184 row_ror:8 row_mask:0xf bank_mask:0xc
    v_mov_b32_dpp v177, v185 row_ror:8 row_mask:0xf bank_mask:0xc
    v_mov_b32_dpp v178, v186 row_ror:8 row_mask:0xf bank_mask:0xc
    v_mov_b32_dpp v179, v187 row_ror:8 row_mask:0xf bank_mask:0xc
    v_mov_b32_dpp v184, v12 row_ror:8 row_mask:0xf bank_mask:0x3
    v_mov_b32_dpp v185, v13 row_ror:8 row_mask:0xf bank_mask:0x3
    v_mov_b32_dpp v186, v14 row_ror:8 row_mask:0xf bank_mask:0x3
    v_mov_b32_dpp v187, v15 row_ror:8 row_mask:0xf bank_mask:0x3
    s_and_b32 s60, s55, 3
    s_lshl_b32 s60, s60, 1
    s_lshr_b32 s61, s55, 6
    s_add_u32 s60, s60, s61
    s_lshl_b32 s97, s60, 7
    v_and_b32 v113, 31, v0
    v_lshlrev_b32 v113, 2, v113
    s_waitcnt vmcnt(4)
    s_cbranch_vccnz L_pf18
    s_waitcnt vmcnt(3)
L_pf18:
    s_add_u32 s101, s100, 131072
    buffer_load_dwordx4 v[196:199], v2, s[24:27], s101 offen offset:128 nt
    s_barrier
    s_lshl_b32 s98, s45, 18
    s_lshl_b32 s60, s54, 17
    s_add_u32 s98, s98, s60
    s_lshl_b32 s60, s46, 13
    s_add_u32 s98, s98, s60
    s_lshr_b32 s60, s53, 1
    s_lshl_b32 s60, s60, 12
    s_add_u32 s98, s98, s60
    s_and_b32 s60, s53, 1
    s_lshl_b32 s60, s60, 10
    s_add_u32 s98, s98, s60
    s_add_u32 s98, s98, 3145728
    s_lshl_b32 s32, s54, 14
    s_lshl_b32 s61, s53, 10
    s_add_u32 s32, s32, s61
    s_lshl_b32 s33, s54, 14
    s_lshl_b32 s2, s45, 16
    s_lshl_b32 s60, s54, 15
    s_add_u32 s2, s2, s60
    s_lshl_b32 s60, s44, 7
    s_add_u32 s2, s2, s60
    s_lshl_b32 s60, s53, 13
    s_add_u32 s2, s2, s60
    s_waitcnt vmcnt(4)
    s_cbranch_vccnz L_pf19
    s_waitcnt vmcnt(3)
L_pf19:
    s_add_u32 s101, s100, 135168
    buffer_load_dwordx4 v[204:207], v2, s[24:27], s101 offen offset:128 nt
    s_barrier
    v_mov_b32 v12, v180
    v_mov_b32 v13, v181
    v_mov_b32 v14, v182
    v_mov_b32 v15, v183
    v_mov_b32_dpp v180, v188 row_ror:8 row_mask:0xf bank_mask:0xc
    v_mov_b32_dpp v181, v189 row_ror:8 row_mask:0xf bank_mask:0xc
    v_mov_b32_dpp v182, v190 row_ror:8 row_mask:0xf bank_mask:0xc
    v_mov_b32_dpp v183, v191 row_ror:8 row_mask:0xf bank_mask:0xc
    v_mov_b32_dpp v188, v12 row_ror:8 row_mask:0xf bank_mask:0x3
    v_mov_b32_dpp v189, v13 row_ror:8 row_mask:0xf bank_mask:0x3
    v_mov_b32_dpp v190, v14 row_ror:8 row_mask:0xf bank_mask:0x3
    v_mov_b32_dpp v191, v15 row_ror:8 row_mask:0xf bank_mask:0x3
    s_lshl_b32 s60, s52, 11
    v_add_u32 v4, s60, v1
    v_mov_b32 v8, s58
    s_mov_b32 s34, 0x07060500
    s_mov_b32 s35, 0x0c0c0400
    v_mov_b32 v24, 0x3f803f80
    v_mov_b32 v25, 0x3f803f80
    v_mov_b32 v26, 0x3f803f80
    v_mov_b32 v27, 0x3f803f80
    s_waitcnt vmcnt(4)
    s_cbranch_vccnz L_pf20
    s_waitcnt vmcnt(2)
L_pf20:
    s_sub_u32 m0, s10, 49152
    s_mul_i32 s101, s89, 8
    s_add_u32 s101, s101, s13
    buffer_load_dwordx4 v9, s[36:39], s101 offen sc1 lds
    s_add_u32 s101, s100, 131072
    buffer_load_dwordx4 v[208:211], v2, s[24:27], s101 offen offset:1024 nt
    s_barrier
    s_lshl_b32 s3, s45, 4
    s_add_u32 s3, s3, s44
    s_lshl_b32 s3, s3, 3
    s_add_u32 s3, s3, s52
    s_lshl_b32 s3, s3, 12
    s_add_u32 s3, s3, 4194304
    s_add_u32 s60, s46, 1
    s_and_b32 s60, s60, 3
    s_lshl_b32 s60, s60, 10
    s_add_u32 s92, s3, s60
    s_add_u32 s60, s46, 2
    s_and_b32 s60, s60, 3
    s_lshl_b32 s60, s60, 10
    s_add_u32 s93, s3, s60
    s_add_u32 s60, s46, 3
    s_and_b32 s60, s60, 3
    s_lshl_b32 s60, s60, 10
    s_add_u32 s96, s3, s60
    s_lshl_b32 s60, s46, 10
    s_add_u32 s3, s3, s60
    s_waitcnt vmcnt(4)
    s_cbranch_vccnz L_pf21
    s_waitcnt vmcnt(3)
L_pf21:
    s_add_u32 s101, s100, 135168
    buffer_load_dwordx4 v[216:219], v2, s[24:27], s101 offen offset:1024 nt
    s_barrier
    v_mov_b32 v12, v192
    v_mov_b32 v13, v193
    v_mov_b32 v14, v194
    v_mov_b32 v15, v195
    v_mov_b32_dpp v192, v200 row_ror:8 row_mask:0xf bank_mask:0xc
    v_mov_b32_dpp v193, v201 row_ror:8 row_mask:0xf bank_mask:0xc
    v_mov_b32_dpp v194, v202 row_ror:8 row_mask:0xf bank_mask:0xc
    v_mov_b32_dpp v195, v203 row_ror:8 row_mask:0xf bank_mask:0xc
    v_mov_b32_dpp v200, v12 row_ror:8 row_mask:0xf bank_mask:0x3
    v_mov_b32_dpp v201, v13 row_ror:8 row_mask:0xf bank_mask:0x3
    v_mov_b32_dpp v202, v14 row_ror:8 row_mask:0xf bank_mask:0x3
    v_mov_b32_dpp v203, v15 row_ror:8 row_mask:0xf bank_mask:0x3
    s_lshr_b32 s60, s55, 5
    s_lshl_b32 s60, s60, 2
    s_and_b32 s61, s55, 3
    s_add_u32 s60, s60, s61
    s_lshl_b32 s60, s60, 7
    s_bfe_u32 s61, s55, 0x30002
    s_lshl_b32 s61, s61, 1
    s_add_u32 s61, s61, s56
    s_lshl_b32 s61, s61, 2
    s_add_u32 s60, s60, s61
    s_add_u32 s60, s60, 4096
    s_cmp_eq_u32 s52, 0
    s_cselect_b32 s5, s60, 0x10000000
    s_lshl_b32 s60, s45, 2
    s_add_u32 s60, s60, s46
    s_lshl_b32 s60, s60, 7
    s_lshl_b32 s61, s54, 5
    s_add_u32 s60, s60, s61
    s_add_u32 s6, s60, 4096
    s_waitcnt vmcnt(4)
    s_cbranch_vccnz L_pf22
    s_waitcnt vmcnt(3)
L_pf22:
    s_add_u32 s101, s100, 131072
    buffer_load_dwordx4 v[212:215], v2, s[24:27], s101 offen offset:1152 nt
    s_barrier
    s_add_u32 s20, s16, 6291456
    s_lshl_b32 s22, s4, 9
    s_lshl_b32 s60, s54, 8
    s_add_u32 s22, s22, s60
    s_add_u32 s22, s22, 65536
    s_cmp_eq_u32 s53, 0
    s_cselect_b32 s21, s22, 0x10000000
    s_xor_b32 s22, s22, 4096
    s_xor_b32 s23, s16, 65536
    s_add_u32 s23, s23, 6291456
    s_waitcnt vmcnt(4)
    s_cbranch_vccnz L_pf23
    s_waitcnt vmcnt(2)
L_pf23:
    s_sub_u32 m0, s10, 40960
    s_mul_i32 s101, s89, 12
    s_add_u32 s101, s101, s13
    buffer_load_dwordx4 v9, s[36:39], s101 offen sc1 lds
    s_add_u32 s101, s100, 135168
    buffer_load_dwordx4 v[220:223], v2, s[24:27], s101 offen offset:1152 nt
    s_barrier
    v_mov_b32 v12, v196
    v_mov_b32 v13, v197
    v_mov_b32 v14, v198
    v_mov_b32 v15, v199
    v_mov_b32_dpp v196, v204 row_ror:8 row_mask:0xf bank_mask:0xc
    v_mov_b32_dpp v197, v205 row_ror:8 row_mask:0xf bank_mask:0xc
    v_mov_b32_dpp v198, v206 row_ror:8 row_mask:0xf bank_mask:0xc
    v_mov_b32_dpp v199, v207 row_ror:8 row_mask:0xf bank_mask:0xc
    v_mov_b32_dpp v204, v12 row_ror:8 row_mask:0xf bank_mask:0x3
    v_mov_b32_dpp v205, v13 row_ror:8 row_mask:0xf bank_mask:0x3
    v_mov_b32_dpp v206, v14 row_ror:8 row_mask:0xf bank_mask:0x3
    v_mov_b32_dpp v207, v15 row_ror:8 row_mask:0xf bank_mask:0x3
    s_waitcnt vmcnt(4)
    s_cbranch_vccnz L_pf24
    s_waitcnt vmcnt(3)
L_pf24:
    s_cmp_lg_u32 s52, 1
    s_cbranch_scc1 L_ow_qp
    buffer_load_dword v112, v113, s[48:51], s97 offen offset:1024 sc1
L_ow_qp:
    s_add_u32 s101, s100, 196608
    buffer_load_dwordx4 v[224:227], v2, s[24:27], s101 offen offset:0 nt
    s_barrier
    s_waitcnt vmcnt(4)
    s_cbranch_vccnz L_pf25
    s_waitcnt vmcnt(3)
L_pf25:
    s_add_u32 s101, s100, 200704
    buffer_load_dwordx4 v[232:235], v2, s[24:27], s101 offen offset:0 nt
    s_barrier
    v_mov_b32 v12, v208
    v_mov_b32 v13, v209
    v_mov_b32 v14, v210
    v_mov_b32 v15, v211
    v_mov_b32_dpp v208, v216 row_ror:8 row_mask:0xf bank_mask:0xc
    v_mov_b32_dpp v209, v217 row_ror:8 row_mask:0xf bank_mask:0xc
    v_mov_b32_dpp v210, v218 row_ror:8 row_mask:0xf bank_mask:0xc
    v_mov_b32_dpp v211, v219 row_ror:8 row_mask:0xf bank_mask:0xc
    v_mov_b32_dpp v216, v12 row_ror:8 row_mask:0xf bank_mask:0x3
    v_mov_b32_dpp v217, v13 row_ror:8 row_mask:0xf bank_mask:0x3
    v_mov_b32_dpp v218, v14 row_ror:8 row_mask:0xf bank_mask:0x3
    v_mov_b32_dpp v219, v15 row_ror:8 row_mask:0xf bank_mask:0x3
    s_waitcnt vmcnt(4)
    s_cbranch_vccnz L_pf26
    s_waitcnt vmcnt(2)
L_pf26:
    s_sub_u32 m0, s10, 32768
    s_mul_i32 s101, s89, 64
    s_add_u32 s101, s101, s13
    buffer_load_dwordx4 v9, s[36:39], s101 offen sc1 lds
    s_add_u32 s101, s100, 196608
    buffer_load_dwordx4 v[228:231], v2, s[24:27], s101 offen offset:128 nt
    s_barrier
    s_waitcnt vmcnt(4)
    s_cbranch_vccnz L_pf27
    s_waitcnt vmcnt(3)
L_pf27:
    s_add_u32 s101, s100, 200704
    buffer_load_dwordx4 v[236:239], v2, s[24:27], s101 offen offset:128 nt
    s_waitcnt vmcnt(4)
    s_cmp_lg_u32 s52, 1
    s_cbranch_scc1 L_ow_qc
    v_cmp_ne_u32 s[94:95], s58, v112
    s_nop 0
    s_cmp_eq_u64 s[94:95], 0
    s_cbranch_scc0 L_spin_q
L_back_q:
L_ow_qc:
    s_barrier
    s_lshl_b32 s60, s52, 10
    s_add_u32 s60, s60, s15
    s_add_u32 s60, s60, 1048576
    s_add_u32 s61, s60, 1048576
    buffer_load_dwordx4 v[96:99], v1, s[48:51], s60 offen sc1
    buffer_load_dwordx4 v[100:103], v1, s[48:51], s61 offen sc1
    v_mov_b32 v12, v212
    v_mov_b32 v13, v213
    v_mov_b32 v14, v214
    v_mov_b32 v15, v215
    v_mov_b32_dpp v212, v220 row_ror:8 row_mask:0xf bank_mask:0xc
    v_mov_b32_dpp v213, v221 row_ror:8 row_mask:0xf bank_mask:0xc
    v_mov_b32_dpp v214, v222 row_ror:8 row_mask:0xf bank_mask:0xc
    v_mov_b32_dpp v215, v223 row_ror:8 row_mask:0xf bank_mask:0xc
    v_mov_b32_dpp v220, v12 row_ror:8 row_mask:0xf bank_mask:0x3
    v_mov_b32_dpp v221, v13 row_ror:8 row_mask:0xf bank_mask:0x3
    v_mov_b32_dpp v222, v14 row_ror:8 row_mask:0xf bank_mask:0x3
    v_mov_b32_dpp v223, v15 row_ror:8 row_mask:0xf bank_mask:0x3
    s_cbranch_vccnz L_pf28
    s_waitcnt vmcnt(5)
L_pf28:
    s_add_u32 s101, s100, 196608
    buffer_load_dwordx4 v[240:243], v2, s[24:27], s101 offen offset:1024 nt
    s_barrier
    s_waitcnt vmcnt(6)
    s_cbranch_vccnz L_pf29
    s_waitcnt vmcnt(4)
L_pf29:
    s_sub_u32 m0, s10, 24576
    s_mul_i32 s101, s89, 68
    s_add_u32 s101, s101, s13
    buffer_load_dwordx4 v9, s[36:39], s101 offen sc1 lds
    s_add_u32 s101, s100, 200704
    buffer_load_dwordx4 v[248:251], v2, s[24:27], s101 offen offset:1024 nt
    s_barrier
    v_mov_b32 v12, v224
    v_mov_b32 v13, v225
    v_mov_b32 v14, v226
    v_mov_b32 v15, v227
    v_mov_b32_dpp v224, v232 row_ror:8 row_mask:0xf bank_mask:0xc
    v_mov_b32_dpp v225, v233 row_ror:8 row_mask:0xf bank_mask:0xc
    v_mov_b32_dpp v226, v234 row_ror:8 row_mask:0xf bank_mask:0xc
    v_mov_b32_dpp v227, v235 row_ror:8 row_mask:0xf bank_mask:0xc
    v_mov_b32_dpp v232, v12 row_ror:8 row_mask:0xf bank_mask:0x3
    v_mov_b32_dpp v233, v13 row_ror:8 row_mask:0xf bank_mask:0x3
    v_mov_b32_dpp v234, v14 row_ror:8 row_mask:0xf bank_mask:0x3
    v_mov_b32_dpp v235, v15 row_ror:8 row_mask:0xf bank_mask:0x3
    s_waitcnt vmcnt(6)
    s_cbranch_vccnz L_pf30
    s_waitcnt vmcnt(5)
L_pf30:
    s_add_u32 s101, s100, 196608
    buffer_load_dwordx4 v[244:247], v2, s[24:27], s101 offen offset:1152 nt
    s_barrier
    s_waitcnt vmcnt(6)
    s_cbranch_vccnz L_pf31
    s_waitcnt vmcnt(3)
L_pf31:
    s_add_u32 s101, s100, 200704
    buffer_load_dwordx4 v[252:255], v2, s[24:27], s101 offen offset:1152 nt
    s_mov_b32 s62, 0xffff0000
    s_waitcnt vmcnt(6)
    v_lshlrev_b32 v12, 16, v96
    s_waitcnt vmcnt(5)
    v_lshlrev_b32 v13, 16, v100
    v_and_b32 v96, s62, v96
    v_and_b32 v100, s62, v100
    v_add_f32 v12, v12, v13
    v_add_f32 v96, v96, v100
    v_cvt_pk_bf16_f32 v104, v12, v96
    v_lshlrev_b32 v12, 16, v97
    v_lshlrev_b32 v13, 16, v101
    v_and_b32 v97, s62, v97
    v_and_b32 v101, s62, v101
    v_add_f32 v12, v12, v13
    v_add_f32 v97, v97, v101
    v_cvt_pk_bf16_f32 v105, v12, v97
    v_lshlrev_b32 v12, 16, v98
    v_lshlrev_b32 v13, 16, v102
    v_and_b32 v98, s62, v98
    v_and_b32 v102, s62, v102
    v_add_f32 v12, v12, v13
    v_add_f32 v98, v98, v102
    v_cvt_pk_bf16_f32 v106, v12, v98
    v_lshlrev_b32 v12, 16, v99
    v_lshlrev_b32 v13, 16, v103
    v_and_b32 v99, s62, v99
    v_and_b32 v103, s62, v103
    v_add_f32 v12, v12, v13
    v_add_f32 v99, v99, v103
    v_cvt_pk_bf16_f32 v107, v12, v99
    s_lshl_b32 s60, s52, 10
    s_add_u32 s60, s60, 147456
    v_add_u32 v12, s60, v1
    ds_write_b128 v12, v[104:107]
    s_waitcnt lgkmcnt(0)
    s_barrier
    v_add_u32 v80, 0x24000, v7
    ds_read_b128 v[32:35], v80 offset:0
    ds_read_b128 v[48:51], v80 offset:4096
    ds_read_b128 v[36:39], v80 offset:256
    v_mov_b32 v12, v228
    v_mov_b32 v13, v229
    ds_read_b128 v[52:55], v80 offset:4352
    v_mov_b32 v14, v230
    v_mov_b32 v15, v231
    ds_read_b128 v[40:43], v80 offset:512
    v_mov_b32_dpp v228, v236 row_ror:8 row_mask:0xf bank_mask:0xc
    v_mov_b32_dpp v229, v237 row_ror:8 row_mask:0xf bank_mask:0xc
    ds_read_b128 v[56:59], v80 offset:4608
    v_mov_b32_dpp v230, v238 row_ror:8 row_mask:0xf bank_mask:0xc
    v_mov_b32_dpp v231, v239 row_ror:8 row_mask:0xf bank_mask:0xc
    ds_read_b128 v[44:47], v80 offset:768
    v_mov_b32_dpp v236, v12 row_ror:8 row_mask:0xf bank_mask:0x3
    v_mov_b32_dpp v237, v13 row_ror:8 row_mask:0xf bank_mask:0x3
    ds_read_b128 v[60:63], v80 offset:4864
    v_mov_b32_dpp v238, v14 row_ror:8 row_mask:0xf bank_mask:0x3
    v_mov_b32_dpp v239, v15 row_ror:8 row_mask:0xf bank_mask:0x3
    s_waitcnt lgkmcnt(7)
    v_mfma_f32_16x16x32_bf16 v[64:67], v[128:131], v[32:35], 0
    s_waitcnt lgkmcnt(6)
    v_mfma_f32_16x16x32_bf16 v[68:71], v[128:131], v[48:51], 0
    s_waitcnt lgkmcnt(5)
    v_mfma_f32_16x16x32_bf16 v[64:67], v[136:139], v[36:39], v[64:67]
    s_waitcnt lgkmcnt(4)
    v_mfma_f32_16x16x32_bf16 v[68:71], v[136:139], v[52:55], v[68:71]
    s_waitcnt lgkmcnt(3)
    v_mfma_f32_16x16x32_bf16 v[64:67], v[132:135], v[40:43], v[64:67]
    s_waitcnt lgkmcnt(2)
    v_mfma_f32_16x16x32_bf16 v[68:71], v[132:135], v[56:59], v[68:71]
    s_waitcnt lgkmcnt(1)
    v_mfma_f32_16x16x32_bf16 v[64:67], v[140:143], v[44:47], v[64:67]
    s_waitcnt lgkmcnt(0)
    v_mfma_f32_16x16x32_bf16 v[68:71], v[140:143], v[60:63], v[68:71]
    s_waitcnt vmcnt(4)
    s_cbranch_vccnz L_pf32
    s_waitcnt vmcnt(2)
L_pf32:
    s_sub_u32 m0, s10, 16384
    s_mul_i32 s101, s89, 72
    s_add_u32 s101, s101, s13
    buffer_load_dwordx4 v9, s[36:39], s101 offen sc1 lds
    s_add_u32 m0, s10, 0
    s_add_u32 s101, s11, 0
    buffer_load_dwordx4 v3, s[28:31], s101 offen nt lds
    s_barrier
    v_mfma_f32_16x16x32_bf16 v[72:75], v[144:147], v[32:35], 0
    v_mfma_f32_16x16x32_bf16 v[76:79], v[144:147], v[48:51], 0
    v_mfma_f32_16x16x32_bf16 v[72:75], v[152:155], v[36:39], v[72:75]
    v_mfma_f32_16x16x32_bf16 v[76:79], v[152:155], v[52:55], v[76:79]
    v_mfma_f32_16x16x32_bf16 v[72:75], v[148:151], v[40:43], v[72:75]
    v_mfma_f32_16x16x32_bf16 v[76:79], v[148:151], v[56:59], v[76:79]
    v_mfma_f32_16x16x32_bf16 v[72:75], v[156:159], v[44:47], v[72:75]
    v_mfma_f32_16x16x32_bf16 v[76:79], v[156:159], v[60:63], v[76:79]
    v_max3_f32 v12, v64, v65, v66
    s_nop 5
    v_max3_f32 v14, v67, v72, v73
    v_max3_f32 v13, v68, v69, v70
    v_max3_f32 v15, v71, v76, v77
    v_max3_f32 v12, v12, v74, v75
    v_max3_f32 v13, v13, v78, v79
    v_max_f32 v12, v12, v14
    v_max_f32 v13, v13, v15
    ds_max_f32 v11, v12 offset:0
    ds_max_f32 v11, v13 offset:4
    s_waitcnt vmcnt(4)
    s_cbranch_vccnz L_pf33
    s_waitcnt vmcnt(3)
L_pf33:
    s_add_u32 m0, s10, 8192
    s_add_u32 s101, s11, 16384
    buffer_load_dwordx4 v3, s[28:31], s101 offen nt lds
    s_waitcnt lgkmcnt(0)
    s_barrier
    ds_read_b64 v[88:89], v11
    ds_read_b64_tr_b16 v[128:129], v120 offset:0
    ds_read_b64_tr_b16 v[132:133], v121 offset:0
    ds_read_b64_tr_b16 v[136:137], v122 offset:0
    v_mov_b32 v12, v240
    v_mov_b32 v13, v241
    ds_read_b64_tr_b16 v[140:141], v123 offset:0
    v_mov_b32 v14, v242
    v_mov_b32 v15, v243
    v_mov_b32_dpp v240, v248 row_ror:8 row_mask:0xf bank_mask:0xc
    v_mov_b32_dpp v241, v249 row_ror:8 row_mask:0xf bank_mask:0xc
    v_mov_b32_dpp v242, v250 row_ror:8 row_mask:0xf bank_mask:0xc
    v_mov_b32_dpp v243, v251 row_ror:8 row_mask:0xf bank_mask:0xc
    v_mov_b32_dpp v248, v12 row_ror:8 row_mask:0xf bank_mask:0x3
    v_mov_b32_dpp v249, v13 row_ror:8 row_mask:0xf bank_mask:0x3
    v_mov_b32_dpp v250, v14 row_ror:8 row_mask:0xf bank_mask:0x3
    v_mov_b32_dpp v251, v15 row_ror:8 row_mask:0xf bank_mask:0x3
    s_waitcnt lgkmcnt(4)
    v_mul_f32 v18, s59, v88
    v_mul_f32 v19, s59, v89
    v_fma_f32 v64, v64, s59, -v18
    v_fma_f32 v65, v65, s59, -v18
    v_fma_f32 v66, v66, s59, -v18
    v_fma_f32 v67, v67, s59, -v18
    v_fma_f32 v72, v72, s59, -v18
    v_fma_f32 v73, v73, s59, -v18
    v_fma_f32 v74, v74, s59, -v18
    v_fma_f32 v75, v75, s59, -v18
    v_exp_f32 v64, v64
    v_exp_f32 v65, v65
    v_exp_f32 v66, v66
    v_exp_f32 v67, v67
    v_exp_f32 v72, v72
    v_exp_f32 v73, v73
    v_exp_f32 v74, v74
    v_exp_f32 v75, v75
    v_cvt_pk_bf16_f32 v80, v64, v65
    v_cvt_pk_bf16_f32 v81, v66, v67
    v_cvt_pk_bf16_f32 v82, v72, v73
    v_cvt_pk_bf16_f32 v83, v74, v75
    ds_write_b128 v4, v[80:83] offset:0
    s_waitcnt vmcnt(4)
    s_cbranch_vccnz L_pf34
    s_waitcnt vmcnt(3)
L_pf34:
    s_add_u32 m0, s10, 16384
    s_add_u32 s101, s11, 32768
    buffer_load_dwordx4 v3, s[28:31], s101 offen nt lds
    s_waitcnt lgkmcnt(0)
    s_barrier
    ds_read_b64_tr_b16 v[130:131], v120 offset:8192
    v_fma_f32 v68, v68, s59, -v19
    v_fma_f32 v69, v69, s59, -v19
    ds_read_b64_tr_b16 v[134:135], v121 offset:8192
    v_fma_f32 v70, v70, s59, -v19
    v_fma_f32 v71, v71, s59, -v19
    ds_read_b64_tr_b16 v[138:139], v122 offset:8192
    v_fma_f32 v76, v76, s59, -v19
    v_fma_f32 v77, v77, s59, -v19
    ds_read_b64_tr_b16 v[142:143], v123 offset:8192
    v_fma_f32 v78, v78, s59, -v19
    v_fma_f32 v79, v79, s59, -v19
    v_exp_f32 v68, v68
    v_exp_f32 v69, v69
    v_exp_f32 v70, v70
    v_exp_f32 v71, v71
    v_exp_f32 v76, v76
    v_exp_f32 v77, v77
    v_exp_f32 v78, v78
    v_exp_f32 v79, v79
    v_cvt_pk_bf16_f32 v84, v68, v69
    v_cvt_pk_bf16_f32 v85, v70, v71
    v_cvt_pk_bf16_f32 v86, v76, v77
    v_cvt_pk_bf16_f32 v87, v78, v79
    ds_write_b128 v4, v[84:87] offset:1024
    s_waitcnt vmcnt(4)
    s_cbranch_vccnz L_pf35
    s_waitcnt vmcnt(2)
L_pf35:
    s_sub_u32 m0, s10, 8192
    s_mul_i32 s101, s89, 76
    s_add_u32 s101, s101, s13
    buffer_load_dwordx4 v9, s[36:39], s101 offen sc1 lds
    s_add_u32 m0, s10, 24576
    s_add_u32 s101, s11, 49152
    buffer_load_dwordx4 v3, s[28:31], s101 offen nt lds
    s_waitcnt lgkmcnt(0)
    s_barrier
    ds_read_b64_tr_b16 v[144:145], v120 offset:16384
    v_mov_b32 v12, v244
    v_mov_b32 v13, v245
    ds_read_b64_tr_b16 v[148:149], v121 offset:16384
    v_mov_b32 v14, v246
    v_mov_b32 v15, v247
    ds_read_b64_tr_b16 v[152:153], v122 offset:16384
    v_mov_b32_dpp v244, v252 row_ror:8 row_mask:0xf bank_mask:0xc
    v_mov_b32_dpp v245, v253 row_ror:8 row_mask:0xf bank_mask:0xc
    ds_read_b64_tr_b16 v[156:157], v123 offset:16384
    v_mov_b32_dpp v246, v254 row_ror:8 row_mask:0xf bank_mask:0xc
    v_mov_b32_dpp v247, v255 row_ror:8 row_mask:0xf bank_mask:0xc
    v_mov_b32_dpp v252, v12 row_ror:8 row_mask:0xf bank_mask:0x3
    v_mov_b32_dpp v253, v13 row_ror:8 row_mask:0xf bank_mask:0x3
    v_mov_b32_dpp v254, v14 row_ror:8 row_mask:0xf bank_mask:0x3
    v_mov_b32_dpp v255, v15 row_ror:8 row_mask:0xf bank_mask:0x3
    v_mfma_f32_16x16x32_bf16 v[64:67], v[160:163], v[32:35], 0
    v_mfma_f32_16x16x32_bf16 v[68:71], v[160:163], v[48:51], 0
    v_mfma_f32_16x16x32_bf16 v[64:67], v[168:171], v[36:39], v[64:67]
    v_mfma_f32_16x16x32_bf16 v[68:71], v[168:171], v[52:55], v[68:71]
    v_mfma_f32_16x16x32_bf16 v[64:67], v[164:167], v[40:43], v[64:67]
    v_mfma_f32_16x16x32_bf16 v[68:71], v[164:167], v[56:59], v[68:71]
    v_mfma_f32_16x16x32_bf16 v[64:67], v[172:175], v[44:47], v[64:67]
    v_mfma_f32_16x16x32_bf16 v[68:71], v[172:175], v[60:63], v[68:71]
    s_waitcnt vmcnt(4)
    s_cbranch_vccnz L_pf36
    s_waitcnt vmcnt(3)
L_pf36:
    s_add_u32 m0, s10, 32768
    s_add_u32 s101, s11, 65536
    buffer_load_dwordx4 v3, s[28:31], s101 offen nt lds
    s_waitcnt lgkmcnt(0)
    s_barrier
    ds_read_b64_tr_b16 v[96:97], v5 offset:0
    v_mfma_f32_16x16x32_bf16 v[72:75], v[176:179], v[32:35], 0
    ds_read_b64_tr_b16 v[98:99], v5 offset:512
    v_mfma_f32_16x16x32_bf16 v[76:79], v[176:179], v[48:51], 0
    ds_read_b128 v[100:103], v6 offset:0
    v_mfma_f32_16x16x32_bf16 v[72:75], v[184:187], v[36:39], v[72:75]
    ds_read_b64_tr_b16 v[104:105], v5 offset:4096
    v_mfma_f32_16x16x32_bf16 v[76:79], v[184:187], v[52:55], v[76:79]
    ds_read_b64_tr_b16 v[106:107], v5 offset:4608
    v_mfma_f32_16x16x32_bf16 v[72:75], v[180:183], v[40:43], v[72:75]
    ds_read_b128 v[108:111], v6 offset:2048
    v_mfma_f32_16x16x32_bf16 v[76:79], v[180:183], v[56:59], v[76:79]
    ds_read_b64_tr_b16 v[146:147], v120 offset:24576
    v_mfma_f32_16x16x32_bf16 v[72:75], v[188:191], v[44:47], v[72:75]
    ds_read_b64_tr_b16 v[150:151], v121 offset:24576
    v_mfma_f32_16x16x32_bf16 v[76:79], v[188:191], v[60:63], v[76:79]
    ds_read_b64_tr_b16 v[154:155], v122 offset:24576
    ds_read_b64_tr_b16 v[158:159], v123 offset:24576
    s_waitcnt lgkmcnt(7)
    v_mfma_f32_16x16x32_bf16 v[20:23], v[96:99], v[100:103], 0
    v_mfma_f32_16x16x32_bf16 v[28:31], v[24:27], v[100:103], 0
    s_waitcnt lgkmcnt(4)
    v_mfma_f32_16x16x32_bf16 v[20:23], v[104:107], v[108:111], v[20:23]
    v_mfma_f32_16x16x32_bf16 v[28:31], v[24:27], v[108:111], v[28:31]
    v_max3_f32 v12, v64, v65, v66
    v_max3_f32 v14, v67, v72, v73
    v_max3_f32 v13, v68, v69, v70
    v_max3_f32 v15, v71, v76, v77
    v_max3_f32 v12, v12, v74, v75
    v_max3_f32 v13, v13, v78, v79
    v_max_f32 v12, v12, v14
    v_max_f32 v13, v13, v15
    ds_max_f32 v11, v12 offset:0
    ds_max_f32 v11, v13 offset:4
    s_waitcnt vmcnt(4)
    s_cbranch_vccnz L_pf37
    s_waitcnt vmcnt(3)
L_pf37:
    s_add_u32 m0, s10, 40960
    s_add_u32 s101, s11, 81920
    buffer_load_dwordx4 v3, s[28:31], s101 offen nt lds
    s_waitcnt lgkmcnt(0)
    s_barrier
    ds_read_b64 v[88:89], v11
    ds_read_b64_tr_b16 v[96:97], v5 offset:8192
    ds_read_b64_tr_b16 v[98:99], v5 offset:8704
    ds_read_b128 v[100:103], v6 offset:4096
    v_cndmask_b32 v12, v19, v18, s[18:19]
    s_waitcnt lgkmcnt(3)
    v_mul_f32 v18, s59, v88
    ds_read_b64_tr_b16 v[104:105], v5 offset:12288
    v_mul_f32 v19, s59, v89
    v_cndmask_b32 v13, v19, v18, s[18:19]
    ds_read_b64_tr_b16 v[106:107], v5 offset:12800
    v_sub_f32 v12, v12, v13
    v_exp_f32 v124, v12
    ds_read_b128 v[108:111], v6 offset:6144
    v_fma_f32 v64, v64, s59, -v18
    v_fma_f32 v65, v65, s59, -v18
    ds_read_b64_tr_b16 v[160:161], v120 offset:32768
    v_fma_f32 v66, v66, s59, -v18
    v_fma_f32 v67, v67, s59, -v18
    ds_read_b64_tr_b16 v[164:165], v121 offset:32768
    v_fma_f32 v72, v72, s59, -v18
    v_fma_f32 v73, v73, s59, -v18
    ds_read_b64_tr_b16 v[168:169], v122 offset:32768
    v_fma_f32 v74, v74, s59, -v18
    v_fma_f32 v75, v75, s59, -v18
    ds_read_b64_tr_b16 v[172:173], v123 offset:32768
    v_exp_f32 v64, v64
    v_exp_f32 v65, v65
    s_waitcnt lgkmcnt(7)
    v_mfma_f32_16x16x32_bf16 v[20:23], v[96:99], v[100:103], v[20:23]
    v_exp_f32 v66, v66
    v_exp_f32 v67, v67
    v_mfma_f32_16x16x32_bf16 v[28:31], v[24:27], v[100:103], v[28:31]
    v_exp_f32 v72, v72
    v_exp_f32 v73, v73
    s_waitcnt lgkmcnt(4)
    v_mfma_f32_16x16x32_bf16 v[20:23], v[104:107], v[108:111], v[20:23]
    v_exp_f32 v74, v74
    v_exp_f32 v75, v75
    v_mfma_f32_16x16x32_bf16 v[28:31], v[24:27], v[108:111], v[28:31]
    v_cvt_pk_bf16_f32 v80, v64, v65
    v_cvt_pk_bf16_f32 v81, v66, v67
    v_cvt_pk_bf16_f32 v82, v72, v73
    v_cvt_pk_bf16_f32 v83, v74, v75
    ds_write_b128 v4, v[80:83] offset:16384
    s_waitcnt vmcnt(4)
    s_cbranch_vccnz L_pf38
    s_waitcnt vmcnt(2)
L_pf38:
    s_add_u32 m0, s10, 49152
    s_add_u32 s101, s11, 98304
    buffer_load_dwordx4 v3, s[28:31], s101 offen nt lds
    s_waitcnt lgkmcnt(0)
    s_barrier
    ds_read_b64_tr_b16 v[96:97], v5 offset:16384
    v_fma_f32 v68, v68, s59, -v19
    v_fma_f32 v69, v69, s59, -v19
    ds_read_b64_tr_b16 v[98:99], v5 offset:16896
    v_fma_f32 v70, v70, s59, -v19
    v_fma_f32 v71, v71, s59, -v19
    ds_read_b128 v[100:103], v6 offset:8192
    v_fma_f32 v76, v76, s59, -v19
    v_fma_f32 v77, v77, s59, -v19
    ds_read_b64_tr_b16 v[104:105], v5 offset:20480
    v_fma_f32 v78, v78, s59, -v19
    v_fma_f32 v79, v79, s59, -v19
    ds_read_b64_tr_b16 v[106:107], v5 offset:20992
    v_exp_f32 v68, v68
    v_exp_f32 v69, v69
    ds_read_b128 v[108:111], v6 offset:10240
    v_exp_f32 v70, v70
    v_exp_f32 v71, v71
    ds_read_b64_tr_b16 v[162:163], v120 offset:40960
    v_exp_f32 v76, v76
    v_exp_f32 v77, v77
    ds_read_b64_tr_b16 v[166:167], v121 offset:40960
    v_exp_f32 v78, v78
    v_exp_f32 v79, v79
    ds_read_b64_tr_b16 v[170:171], v122 offset:40960
    v_cvt_pk_bf16_f32 v84, v68, v69
    v_cvt_pk_bf16_f32 v85, v70, v71
    ds_read_b64_tr_b16 v[174:175], v123 offset:40960
    v_cvt_pk_bf16_f32 v86, v76, v77
    v_cvt_pk_bf16_f32 v87, v78, v79
    s_waitcnt lgkmcnt(7)
    v_mfma_f32_16x16x32_bf16 v[20:23], v[96:99], v[100:103], v[20:23]
    ds_write_b128 v4, v[84:87] offset:17408
    v_mfma_f32_16x16x32_bf16 v[28:31], v[24:27], v[100:103], v[28:31]
    s_waitcnt lgkmcnt(5)
    v_mfma_f32_16x16x32_bf16 v[20:23], v[104:107], v[108:111], v[20:23]
    v_mfma_f32_16x16x32_bf16 v[28:31], v[24:27], v[108:111], v[28:31]
    s_waitcnt vmcnt(3)
    s_cbranch_vccnz L_pf39
    s_waitcnt vmcnt(2)
L_pf39:
    s_cmp_lg_u32 s52, 2
    s_cbranch_scc1 L_ow_ap
    buffer_load_dwordx4 v[92:95], v1, s[48:51], 0 offen offset:1024 sc1
L_ow_ap:
    s_sub_u32 m0, s10, 32768
    s_mul_i32 s101, s89, 16
    s_add_u32 s101, s101, s13
    buffer_load_dwordx4 v9, s[36:39], s101 offen sc1 lds
    s_add_u32 m0, s10, 0
    s_add_u32 s101, s11, 114688
    buffer_load_dwordx4 v3, s[28:31], s101 offen nt lds
    s_waitcnt lgkmcnt(0)
    s_barrier
    ds_read_b64_tr_b16 v[96:97], v5 offset:24576
    v_mfma_f32_16x16x32_bf16 v[64:67], v[192:195], v[32:35], 0
    ds_read_b64_tr_b16 v[98:99], v5 offset:25088
    v_mfma_f32_16x16x32_bf16 v[68:71], v[192:195], v[48:51], 0
    ds_read_b128 v[100:103], v6 offset:12288
    v_mfma_f32_16x16x32_bf16 v[64:67], v[200:203], v[36:39], v[64:67]
    ds_read_b64_tr_b16 v[104:105], v5 offset:28672
    v_mfma_f32_16x16x32_bf16 v[68:71], v[200:203], v[52:55], v[68:71]
    ds_read_b64_tr_b16 v[106:107], v5 offset:29184
    v_mfma_f32_16x16x32_bf16 v[64:67], v[196:199], v[40:43], v[64:67]
    ds_read_b128 v[108:111], v6 offset:14336
    v_mfma_f32_16x16x32_bf16 v[68:71], v[196:199], v[56:59], v[68:71]
    ds_read_b64_tr_b16 v[176:177], v120 offset:49152
    v_mfma_f32_16x16x32_bf16 v[64:67], v[204:207], v[44:47], v[64:67]
    ds_read_b64_tr_b16 v[180:181], v121 offset:49152
    v_mfma_f32_16x16x32_bf16 v[68:71], v[204:207], v[60:63], v[68:71]
    ds_read_b64_tr_b16 v[184:185], v122 offset:49152
    ds_read_b64_tr_b16 v[188:189], v123 offset:49152
    s_waitcnt lgkmcnt(7)
    v_mfma_f32_16x16x32_bf16 v[20:23], v[96:99], v[100:103], v[20:23]
    v_mfma_f32_16x16x32_bf16 v[28:31], v[24:27], v[100:103], v[28:31]
    s_waitcnt lgkmcnt(4)
    v_mfma_f32_16x16x32_bf16 v[20:23], v[104:107], v[108:111], v[20:23]
    v_mfma_f32_16x16x32_bf16 v[28:31], v[24:27], v[108:111], v[28:31]
    s_waitcnt vmcnt(4)
    s_cbranch_vccnz L_pf40
    s_waitcnt vmcnt(3)
L_pf40:
    s_lshl_b32 s60, s17, 7
    s_add_u32 s60, s60, 8192
    v_and_b32 v91, 31, v0
    v_lshlrev_b32 v91, 2, v91
    buffer_load_dword v90, v91, s[48:51], s60 offen sc1
    s_add_u32 m0, s10, 8192
    s_add_u32 s101, s11, 131072
    buffer_load_dwordx4 v3, s[28:31], s101 offen nt lds
    s_waitcnt lgkmcnt(0)
    s_barrier
    ds_read_b64_tr_b16 v[96:97], v5 offset:32768
    v_mfma_f32_16x16x32_bf16 v[72:75], v[208:211], v[32:35], 0
    ds_read_b64_tr_b16 v[98:99], v5 offset:33280
    v_mfma_f32_16x16x32_bf16 v[76:79], v[208:211], v[48:51], 0
    ds_read_b128 v[100:103], v6 offset:16384
    v_mfma_f32_16x16x32_bf16 v[72:75], v[216:219], v[36:39], v[72:75]
    ds_read_b64_tr_b16 v[104:105], v5 offset:36864
    v_mfma_f32_16x16x32_bf16 v[76:79], v[216:219], v[52:55], v[76:79]
    ds_read_b64_tr_b16 v[106:107], v5 offset:37376
    v_mfma_f32_16x16x32_bf16 v[72:75], v[212:215], v[40:43], v[72:75]
    ds_read_b128 v[108:111], v6 offset:18432
    v_mfma_f32_16x16x32_bf16 v[76:79], v[212:215], v[56:59], v[76:79]
    ds_read_b64_tr_b16 v[178:179], v120 offset:57344
    v_mfma_f32_16x16x32_bf16 v[72:75], v[220:223], v[44:47], v[72:75]
    ds_read_b64_tr_b16 v[182:183], v121 offset:57344
    v_mfma_f32_16x16x32_bf16 v[76:79], v[220:223], v[60:63], v[76:79]
    ds_read_b64_tr_b16 v[186:187], v122 offset:57344
    ds_read_b64_tr_b16 v[190:191], v123 offset:57344
    v_mul_f32 v20, v20, v124
    v_mul_f32 v21, v21, v124
    v_mul_f32 v22, v22, v124
    v_mul_f32 v23, v23, v124
    v_mul_f32 v28, v28, v124
    s_waitcnt lgkmcnt(7)
    v_mfma_f32_16x16x32_bf16 v[20:23], v[96:99], v[100:103], v[20:23]
    v_mfma_f32_16x16x32_bf16 v[28:31], v[24:27], v[100:103], v[28:31]
    s_waitcnt lgkmcnt(4)
    v_mfma_f32_16x16x32_bf16 v[20:23], v[104:107], v[108:111], v[20:23]
    v_mfma_f32_16x16x32_bf16 v[28:31], v[24:27], v[108:111], v[28:31]
    v_max3_f32 v12, v64, v65, v66
    v_max3_f32 v14, v67, v72, v73
    v_max3_f32 v13, v68, v69, v70
    v_max3_f32 v15, v71, v76, v77
    v_max3_f32 v12, v12, v74, v75
    v_max3_f32 v13, v13, v78, v79
    v_max_f32 v12, v12, v14
    v_max_f32 v13, v13, v15
    ds_max_f32 v11, v12 offset:0
    ds_max_f32 v11, v13 offset:4
    s_waitcnt vmcnt(5)
    s_cbranch_vccnz L_pf41
    s_waitcnt vmcnt(4)
L_pf41:
    s_sub_u32 m0, s10, 24576
    s_mul_i32 s101, s89, 20
    s_add_u32 s101, s101, s13
    buffer_load_dwordx4 v9, s[36:39], s101 offen sc1 lds
    s_add_u32 m0, s10, 16384
    s_add_u32 s101, s11, 147456
    buffer_load_dwordx4 v3, s[28:31], s101 offen nt lds
    s_waitcnt lgkmcnt(0)
    s_barrier
    ds_read_b64 v[88:89], v11
    ds_read_b64_tr_b16 v[96:97], v5 offset:40960
    ds_read_b64_tr_b16 v[98:99], v5 offset:41472
    ds_read_b128 v[100:103], v6 offset:20480
    v_cndmask_b32 v12, v19, v18, s[18:19]
    s_waitcnt lgkmcnt(3)
    v_mul_f32 v18, s59, v88
    ds_read_b64_tr_b16 v[104:105], v5 offset:45056
    v_mul_f32 v19, s59, v89
    v_cndmask_b32 v13, v19, v18, s[18:19]
    ds_read_b64_tr_b16 v[106:107], v5 offset:45568
    v_sub_f32 v12, v12, v13
    v_exp_f32 v125, v12
    ds_read_b128 v[108:111], v6 offset:22528
    v_fma_f32 v64, v64, s59, -v18
    v_fma_f32 v65, v65, s59, -v18
    s_waitcnt lgkmcnt(3)
    v_mfma_f32_16x16x32_bf16 v[20:23], v[96:99], v[100:103], v[20:23]
    v_fma_f32 v66, v66, s59, -v18
    v_fma_f32 v67, v67, s59, -v18
    v_mfma_f32_16x16x32_bf16 v[28:31], v[24:27], v[100:103], v[28:31]
    v_fma_f32 v72, v72, s59, -v18
    v_fma_f32 v73, v73, s59, -v18
    s_waitcnt lgkmcnt(0)
    v_mfma_f32_16x16x32_bf16 v[20:23], v[104:107], v[108:111], v[20:23]
    v_fma_f32 v74, v74, s59, -v18
    v_fma_f32 v75, v75, s59, -v18
    v_mfma_f32_16x16x32_bf16 v[28:31], v[24:27], v[108:111], v[28:31]
    v_exp_f32 v64, v64
    v_exp_f32 v65, v65
    v_exp_f32 v66, v66
    v_exp_f32 v67, v67
    v_exp_f32 v72, v72
    v_exp_f32 v73, v73
    v_exp_f32 v74, v74
    v_exp_f32 v75, v75
    v_cvt_pk_bf16_f32 v80, v64, v65
    v_cvt_pk_bf16_f32 v81, v66, v67
    v_cvt_pk_bf16_f32 v82, v72, v73
    v_cvt_pk_bf16_f32 v83, v74, v75
    ds_write_b128 v4, v[80:83] offset:32768
    s_waitcnt vmcnt(6)
    s_cbranch_vccnz L_pf42
    s_waitcnt vmcnt(4)
L_pf42:
    s_add_u32 m0, s10, 24576
    s_add_u32 s101, s11, 163840
    buffer_load_dwordx4 v3, s[28:31], s101 offen nt lds
    s_waitcnt lgkmcnt(0)
    s_barrier
    ds_read_b64_tr_b16 v[96:97], v5 offset:49152
    v_fma_f32 v68, v68, s59, -v19
    v_fma_f32 v69, v69, s59, -v19
    ds_read_b64_tr_b16 v[98:99], v5 offset:49664
    v_fma_f32 v70, v70, s59, -v19
    v_fma_f32 v71, v71, s59, -v19
    ds_read_b128 v[100:103], v6 offset:24576
    v_fma_f32 v76, v76, s59, -v19
    v_fma_f32 v77, v77, s59, -v19
    ds_read_b64_tr_b16 v[104:105], v5 offset:53248
    v_fma_f32 v78, v78, s59, -v19
    v_fma_f32 v79, v79, s59, -v19
    ds_read_b64_tr_b16 v[106:107], v5 offset:53760
    v_exp_f32 v68, v68
    v_exp_f32 v69, v69
    ds_read_b128 v[108:111], v6 offset:26624
    v_exp_f32 v70, v70
    v_exp_f32 v71, v71
    s_waitcnt lgkmcnt(3)
    v_mfma_f32_16x16x32_bf16 v[20:23], v[96:99], v[100:103], v[20:23]
    v_exp_f32 v76, v76
    v_exp_f32 v77, v77
    v_mfma_f32_16x16x32_bf16 v[28:31], v[24:27], v[100:103], v[28:31]
    v_exp_f32 v78, v78
    v_exp_f32 v79, v79
    s_waitcnt lgkmcnt(0)
    v_mfma_f32_16x16x32_bf16 v[20:23], v[104:107], v[108:111], v[20:23]
    v_cvt_pk_bf16_f32 v84, v68, v69
    v_cvt_pk_bf16_f32 v85, v70, v71
    v_mfma_f32_16x16x32_bf16 v[28:31], v[24:27], v[108:111], v[28:31]
    v_cvt_pk_bf16_f32 v86, v76, v77
    v_cvt_pk_bf16_f32 v87, v78, v79
    ds_write_b128 v4, v[84:87] offset:33792
    s_waitcnt vmcnt(5)
    s_cbranch_vccnz L_pf43
    s_waitcnt vmcnt(3)
L_pf43:
    s_add_u32 m0, s10, 32768
    s_add_u32 s101, s11, 180224
    buffer_load_dwordx4 v3, s[28:31], s101 offen nt lds
    s_cmp_lg_u32 s52, 2
    s_cbranch_scc1 L_ow_ac
    v_cmp_ne_u32 s[94:95], s58, v92
    v_cmp_ne_u32 s[60:61], s58, v93
    s_nop 0
    s_or_b64 s[94:95], s[94:95], s[60:61]
    v_cmp_ne_u32 s[60:61], s58, v94
    s_nop 0
    s_or_b64 s[94:95], s[94:95], s[60:61]
    v_cmp_ne_u32 s[60:61], s58, v95
    s_nop 0
    s_or_b64 s[94:95], s[94:95], s[60:61]
    s_nop 0
    s_cmp_eq_u64 s[94:95], 0
    s_cbranch_scc0 L_spin_a
L_back_a:
    s_cmp_lg_u32 s4, 0
    s_cbranch_scc1 L_ow_ac
    s_mov_b64 exec, 1
    v_mov_b32 v12, s58
    buffer_store_dword v12, v1, s[48:51], 0 offen offset:0 sc1
    s_mov_b64 exec, -1
L_ow_ac:
    s_waitcnt lgkmcnt(0)
    s_barrier
    ds_read_b64_tr_b16 v[96:97], v5 offset:0
    v_mfma_f32_16x16x32_bf16 v[64:67], v[224:227], v[32:35], 0
    ds_read_b64_tr_b16 v[98:99], v5 offset:512
    v_mfma_f32_16x16x32_bf16 v[68:71], v[224:227], v[48:51], 0
    ds_read_b128 v[100:103], v6 offset:28672
    v_mfma_f32_16x16x32_bf16 v[64:67], v[232:235], v[36:39], v[64:67]
    ds_read_b64_tr_b16 v[104:105], v5 offset:4096
    v_mfma_f32_16x16x32_bf16 v[68:71], v[232:235], v[52:55], v[68:71]
    ds_read_b64_tr_b16 v[106:107], v5 offset:4608
    v_mfma_f32_16x16x32_bf16 v[64:67], v[228:231], v[40:43], v[64:67]
    ds_read_b128 v[108:111], v6 offset:30720
    v_mfma_f32_16x16x32_bf16 v[68:71], v[228:231], v[56:59], v[68:71]
    ds_read_b64_tr_b16 v[192:193], v120 offset:32768
    v_mfma_f32_16x16x32_bf16 v[64:67], v[236:239], v[44:47], v[64:67]
    ds_read_b64_tr_b16 v[196:197], v121 offset:32768
    v_mfma_f32_16x16x32_bf16 v[68:71], v[236:239], v[60:63], v[68:71]
    ds_read_b64_tr_b16 v[200:201], v122 offset:32768
    ds_read_b64_tr_b16 v[204:205], v123 offset:32768
    s_waitcnt lgkmcnt(7)
    v_mfma_f32_16x16x32_bf16 v[20:23], v[96:99], v[100:103], v[20:23]
    v_mfma_f32_16x16x32_bf16 v[28:31], v[24:27], v[100:103], v[28:31]
    s_waitcnt lgkmcnt(4)
    v_mfma_f32_16x16x32_bf16 v[20:23], v[104:107], v[108:111], v[20:23]
    v_mfma_f32_16x16x32_bf16 v[28:31], v[24:27], v[108:111], v[28:31]
    s_waitcnt vmcnt(4)
    s_cbranch_vccnz L_pf44
    s_waitcnt vmcnt(2)
L_pf44:
    s_sub_u32 m0, s10, 16384
    s_mul_i32 s101, s89, 24
    s_add_u32 s101, s101, s13
    buffer_load_dwordx4 v9, s[36:39], s101 offen sc1 lds
    s_add_u32 m0, s10, 40960
    s_add_u32 s101, s11, 196608
    buffer_load_dwordx4 v3, s[28:31], s101 offen nt lds
    s_waitcnt lgkmcnt(0)
    s_barrier
    ds_read_b64_tr_b16 v[96:97], v5 offset:8192
    v_mfma_f32_16x16x32_bf16 v[72:75], v[240:243], v[32:35], 0
    ds_read_b64_tr_b16 v[98:99], v5 offset:8704
    v_mfma_f32_16x16x32_bf16 v[76:79], v[240:243], v[48:51], 0
    ds_read_b128 v[100:103], v6 offset:32768
    v_mfma_f32_16x16x32_bf16 v[72:75], v[248:251], v[36:39], v[72:75]
    ds_read_b64_tr_b16 v[104:105], v5 offset:12288
    v_mfma_f32_16x16x32_bf16 v[76:79], v[248:251], v[52:55], v[76:79]
    ds_read_b64_tr_b16 v[106:107], v5 offset:12800
    v_mfma_f32_16x16x32_bf16 v[72:75], v[244:247], v[40:43], v[72:75]
    ds_read_b128 v[108:111], v6 offset:34816
    v_mfma_f32_16x16x32_bf16 v[76:79], v[244:247], v[56:59], v[76:79]
    v_mul_f32 v20, v20, v125
    v_mul_f32 v21, v21, v125
    v_mul_f32 v22, v22, v125
    v_mul_f32 v23, v23, v125
    v_mul_f32 v28, v28, v125
    s_waitcnt lgkmcnt(3)
    v_mfma_f32_16x16x32_bf16 v[20:23], v[96:99], v[100:103], v[20:23]
    v_mfma_f32_16x16x32_bf16 v[72:75], v[252:255], v[44:47], v[72:75]
    v_mfma_f32_16x16x32_bf16 v[28:31], v[24:27], v[100:103], v[28:31]
    v_mfma_f32_16x16x32_bf16 v[76:79], v[252:255], v[60:63], v[76:79]
    s_waitcnt lgkmcnt(0)
    v_mfma_f32_16x16x32_bf16 v[20:23], v[104:107], v[108:111], v[20:23]
    v_mfma_f32_16x16x32_bf16 v[28:31], v[24:27], v[108:111], v[28:31]
    v_max3_f32 v12, v64, v65, v66
    s_nop 1
    v_max3_f32 v14, v67, v72, v73
    v_max3_f32 v13, v68, v69, v70
    v_max3_f32 v15, v71, v76, v77
    v_max3_f32 v12, v12, v74, v75
    v_max3_f32 v13, v13, v78, v79
    v_max_f32 v12, v12, v14
    v_max_f32 v13, v13, v15
    ds_max_f32 v11, v12 offset:0
    ds_max_f32 v11, v13 offset:4
    v_cmp_ne_u32 s[60:61], s86, v90
    s_nop 0
    s_or_b32 s85, s60, s61
    s_waitcnt vmcnt(4)
    s_cbranch_vccnz L_pf45
    s_waitcnt vmcnt(3)
L_pf45:
    s_add_u32 m0, s10, 49152
    s_add_u32 s101, s11, 212992
    buffer_load_dwordx4 v3, s[28:31], s101 offen nt lds
    s_waitcnt lgkmcnt(0)
    s_barrier
    ds_read_b64 v[88:89], v11
    ds_read_b64_tr_b16 v[96:97], v5 offset:16384
    ds_read_b64_tr_b16 v[98:99], v5 offset:16896
    ds_read_b128 v[100:103], v6 offset:36864
    v_cndmask_b32 v12, v19, v18, s[18:19]
    s_waitcnt lgkmcnt(3)
    v_mul_f32 v18, s59, v88
    ds_read_b64_tr_b16 v[104:105], v5 offset:20480
    v_mul_f32 v19, s59, v89
    v_cndmask_b32 v13, v19, v18, s[18:19]
    ds_read_b64_tr_b16 v[106:107], v5 offset:20992
    v_sub_f32 v12, v12, v13
    v_exp_f32 v126, v12
    ds_read_b128 v[108:111], v6 offset:38912
    v_fma_f32 v64, v64, s59, -v18
    v_fma_f32 v65, v65, s59, -v18
    ds_read_b64_tr_b16 v[194:195], v120 offset:40960
    v_fma_f32 v66, v66, s59, -v18
    v_fma_f32 v67, v67, s59, -v18
    ds_read_b64_tr_b16 v[198:199], v121 offset:40960
    v_fma_f32 v72, v72, s59, -v18
    v_fma_f32 v73, v73, s59, -v18
    ds_read_b64_tr_b16 v[202:203], v122 offset:40960
    v_fma_f32 v74, v74, s59, -v18
    v_fma_f32 v75, v75, s59, -v18
    ds_read_b64_tr_b16 v[206:207], v123 offset:40960
    v_exp_f32 v64, v64
    v_exp_f32 v65, v65
    s_waitcnt lgkmcnt(7)
    v_mfma_f32_16x16x32_bf16 v[20:23], v[96:99], v[100:103], v[20:23]
    v_exp_f32 v66, v66
    v_exp_f32 v67, v67
    v_mfma_f32_16x16x32_bf16 v[28:31], v[24:27], v[100:103], v[28:31]
    v_exp_f32 v72, v72
    v_exp_f32 v73, v73
    s_waitcnt lgkmcnt(4)
    v_mfma_f32_16x16x32_bf16 v[20:23], v[104:107], v[108:111], v[20:23]
    v_exp_f32 v74, v74
    v_exp_f32 v75, v75
    v_mfma_f32_16x16x32_bf16 v[28:31], v[24:27], v[108:111], v[28:31]
    v_cvt_pk_bf16_f32 v80, v64, v65
    v_cvt_pk_bf16_f32 v81, v66, v67
    v_cvt_pk_bf16_f32 v82, v72, v73
    v_cvt_pk_bf16_f32 v83, v74, v75
    ds_write_b128 v4, v[80:83] offset:49152
    s_waitcnt vmcnt(4)
    s_cbranch_vccnz L_pf46
    s_waitcnt vmcnt(3)
L_pf46:
    s_add_u32 m0, s10, 0
    s_add_u32 s101, s11, 229376
    buffer_load_dwordx4 v3, s[28:31], s101 offen nt lds
    s_waitcnt lgkmcnt(0)
    s_barrier
    ds_read_b64_tr_b16 v[96:97], v5 offset:24576
    v_fma_f32 v68, v68, s59, -v19
    v_fma_f32 v69, v69, s59, -v19
    ds_read_b64_tr_b16 v[98:99], v5 offset:25088
    v_fma_f32 v70, v70, s59, -v19
    v_fma_f32 v71, v71, s59, -v19
    ds_read_b128 v[100:103], v6 offset:40960
    v_fma_f32 v76, v76, s59, -v19
    v_fma_f32 v77, v77, s59, -v19
    ds_read_b64_tr_b16 v[104:105], v5 offset:28672
    v_fma_f32 v78, v78, s59, -v19
    v_fma_f32 v79, v79, s59, -v19
    ds_read_b64_tr_b16 v[106:107], v5 offset:29184
    v_exp_f32 v68, v68
    v_exp_f32 v69, v69
    ds_read_b128 v[108:111], v6 offset:43008
    v_exp_f32 v70, v70
    v_exp_f32 v71, v71
    s_waitcnt lgkmcnt(3)
    v_mfma_f32_16x16x32_bf16 v[20:23], v[96:99], v[100:103], v[20:23]
    v_exp_f32 v76, v76
    v_exp_f32 v77, v77
    v_mfma_f32_16x16x32_bf16 v[28:31], v[24:27], v[100:103], v[28:31]
    v_exp_f32 v78, v78
    v_exp_f32 v79, v79
    s_waitcnt lgkmcnt(0)
    v_mfma_f32_16x16x32_bf16 v[20:23], v[104:107], v[108:111], v[20:23]
    v_cvt_pk_bf16_f32 v84, v68, v69
    v_cvt_pk_bf16_f32 v85, v70, v71
    v_mfma_f32_16x16x32_bf16 v[28:31], v[24:27], v[108:111], v[28:31]
    v_cvt_pk_bf16_f32 v86, v76, v77
    v_cvt_pk_bf16_f32 v87, v78, v79
    ds_write_b128 v4, v[84:87] offset:50176
    v_cndmask_b32 v18, v19, v18, s[18:19]
    s_waitcnt vmcnt(4)
    s_cbranch_vccnz L_pf47
    s_waitcnt vmcnt(2)
L_pf47:
    s_sub_u32 m0, s10, 8192
    s_mul_i32 s101, s89, 28
    s_add_u32 s101, s101, s13
    buffer_load_dwordx4 v9, s[36:39], s101 offen sc1 lds
    s_add_u32 m0, s10, 8192
    s_add_u32 s101, s11, 245760
    buffer_load_dwordx4 v3, s[28:31], s101 offen nt lds
    s_waitcnt lgkmcnt(0)
    s_barrier
    ds_read_b64_tr_b16 v[96:97], v5 offset:32768
    v_mov_b32 v48, v18
    v_mov_b32 v49, s58
    ds_read_b64_tr_b16 v[98:99], v5 offset:33280
    v_mov_b32 v51, s58
    v_lshlrev_b32 v58, 4, v16
    ds_read_b128 v[100:103], v6 offset:45056
    ds_read_b64_tr_b16 v[104:105], v5 offset:36864
    ds_read_b64_tr_b16 v[106:107], v5 offset:37376
    ds_read_b128 v[108:111], v6 offset:47104
    s_waitcnt lgkmcnt(3)
    v_mfma_f32_16x16x32_bf16 v[20:23], v[96:99], v[100:103], v[20:23]
    v_mfma_f32_16x16x32_bf16 v[28:31], v[24:27], v[100:103], v[28:31]
    s_waitcnt lgkmcnt(0)
    v_mfma_f32_16x16x32_bf16 v[20:23], v[104:107], v[108:111], v[20:23]
    v_mfma_f32_16x16x32_bf16 v[28:31], v[24:27], v[108:111], v[28:31]
    s_waitcnt vmcnt(4)
    s_cbranch_vccnz L_pf48
    s_waitcnt vmcnt(3)
L_pf48:
    s_add_u32 m0, s10, 16384
    s_add_u32 s101, s12, 0
    buffer_load_dwordx4 v3, s[28:31], s101 offen nt lds
    s_barrier
    ds_read_b64_tr_b16 v[96:97], v5 offset:40960
    ds_read_b64_tr_b16 v[98:99], v5 offset:41472
    ds_read_b128 v[100:103], v6 offset:49152
    ds_read_b64_tr_b16 v[104:105], v5 offset:45056
    ds_read_b64_tr_b16 v[106:107], v5 offset:45568
    ds_read_b128 v[108:111], v6 offset:51200
    ds_read_b64_tr_b16 v[208:209], v120 offset:49152
    ds_read_b64_tr_b16 v[212:213], v121 offset:49152
    ds_read_b64_tr_b16 v[216:217], v122 offset:49152
    ds_read_b64_tr_b16 v[220:221], v123 offset:49152
    v_mul_f32 v20, v20, v126
    v_mul_f32 v21, v21, v126
    v_mul_f32 v22, v22, v126
    v_mul_f32 v23, v23, v126
    v_mul_f32 v28, v28, v126
    s_waitcnt lgkmcnt(7)
    v_mfma_f32_16x16x32_bf16 v[20:23], v[96:99], v[100:103], v[20:23]
    v_mfma_f32_16x16x32_bf16 v[28:31], v[24:27], v[100:103], v[28:31]
    s_waitcnt lgkmcnt(4)
    v_mfma_f32_16x16x32_bf16 v[20:23], v[104:107], v[108:111], v[20:23]
    v_mfma_f32_16x16x32_bf16 v[28:31], v[24:27], v[108:111], v[28:31]
    s_waitcnt vmcnt(4)
    s_cbranch_vccnz L_pf49
    s_waitcnt vmcnt(3)
L_pf49:
    s_add_u32 m0, s10, 24576
    s_add_u32 s101, s12, 16384
    buffer_load_dwordx4 v3, s[28:31], s101 offen nt lds
    s_waitcnt lgkmcnt(0)
    s_barrier
    ds_read_b64_tr_b16 v[96:97], v5 offset:49152
    ds_read_b64_tr_b16 v[98:99], v5 offset:49664
    ds_read_b128 v[100:103], v6 offset:53248
    ds_read_b64_tr_b16 v[104:105], v5 offset:53248
    ds_read_b64_tr_b16 v[106:107], v5 offset:53760
    ds_read_b128 v[108:111], v6 offset:55296
    s_waitcnt lgkmcnt(3)
    v_mfma_f32_16x16x32_bf16 v[20:23], v[96:99], v[100:103], v[20:23]
    v_mfma_f32_16x16x32_bf16 v[28:31], v[24:27], v[100:103], v[28:31]
    s_waitcnt lgkmcnt(0)
    v_mfma_f32_16x16x32_bf16 v[20:23], v[104:107], v[108:111], v[20:23]
    v_mfma_f32_16x16x32_bf16 v[28:31], v[24:27], v[108:111], v[28:31]
    s_waitcnt vmcnt(4)
    s_cbranch_vccnz L_pf50
    s_waitcnt vmcnt(2)
L_pf50:
    s_sub_u32 m0, s10, 32768
    s_mul_i32 s101, s89, 80
    s_add_u32 s101, s101, s13
    buffer_load_dwordx4 v9, s[36:39], s101 offen sc1 lds
    s_add_u32 m0, s10, 32768
    s_add_u32 s101, s12, 32768
    buffer_load_dwordx4 v3, s[28:31], s101 offen nt lds
    s_barrier
    ds_read_b64_tr_b16 v[96:97], v5 offset:0
    ds_read_b64_tr_b16 v[98:99], v5 offset:512
    ds_read_b128 v[100:103], v6 offset:57344
    ds_read_b64_tr_b16 v[104:105], v5 offset:4096
    ds_read_b64_tr_b16 v[106:107], v5 offset:4608
    ds_read_b128 v[108:111], v6 offset:59392
    s_waitcnt lgkmcnt(3)
    v_mfma_f32_16x16x32_bf16 v[20:23], v[96:99], v[100:103], v[20:23]
    v_mfma_f32_16x16x32_bf16 v[28:31], v[24:27], v[100:103], v[28:31]
    s_waitcnt lgkmcnt(0)
    v_mfma_f32_16x16x32_bf16 v[20:23], v[104:107], v[108:111], v[20:23]
    v_mfma_f32_16x16x32_bf16 v[28:31], v[24:27], v[108:111], v[28:31]
    s_waitcnt vmcnt(4)
    s_cbranch_vccnz L_pf51
    s_waitcnt vmcnt(3)
L_pf51:
    s_add_u32 m0, s10, 40960
    s_add_u32 s101, s12, 49152
    buffer_load_dwordx4 v3, s[28:31], s101 offen nt lds
    s_barrier
    ds_read_b64_tr_b16 v[96:97], v5 offset:8192
    ds_read_b64_tr_b16 v[98:99], v5 offset:8704
    ds_read_b128 v[100:103], v6 offset:61440
    ds_read_b64_tr_b16 v[104:105], v5 offset:12288
    ds_read_b64_tr_b16 v[106:107], v5 offset:12800
    ds_read_b128 v[108:111], v6 offset:63488
    ds_read_b64_tr_b16 v[210:211], v120 offset:57344
    ds_read_b64_tr_b16 v[214:215], v121 offset:57344
    ds_read_b64_tr_b16 v[218:219], v122 offset:57344
    ds_read_b64_tr_b16 v[222:223], v123 offset:57344
    s_waitcnt lgkmcnt(7)
    v_mfma_f32_16x16x32_bf16 v[20:23], v[96:99], v[100:103], v[20:23]
    v_mfma_f32_16x16x32_bf16 v[28:31], v[24:27], v[100:103], v[28:31]
    s_waitcnt lgkmcnt(4)
    v_mfma_f32_16x16x32_bf16 v[20:23], v[104:107], v[108:111], v[20:23]
    v_mfma_f32_16x16x32_bf16 v[28:31], v[24:27], v[108:111], v[28:31]
    s_waitcnt vmcnt(4)
    s_cbranch_vccnz L_pf52
    s_waitcnt vmcnt(3)
L_pf52:
    s_add_u32 m0, s10, 49152
    s_add_u32 s101, s12, 65536
    buffer_load_dwordx4 v3, s[28:31], s101 offen nt lds
    s_waitcnt lgkmcnt(0)
    s_barrier
    ds_read_b64_tr_b16 v[96:97], v5 offset:16384
    ds_read_b64_tr_b16 v[98:99], v5 offset:16896
    ds_read_b128 v[100:103], v6 offset:0
    ds_read_b64_tr_b16 v[104:105], v5 offset:20480
    ds_read_b64_tr_b16 v[106:107], v5 offset:20992
    ds_read_b128 v[108:111], v6 offset:2048
    v_perm_b32 v60, v20, v8, s34
    s_add_u32 s62, s34, 1
    v_perm_b32 v61, v21, v8, s62
    s_add_u32 s62, s34, 2
    v_perm_b32 v62, v22, v8, s62
    s_add_u32 s62, s34, 3
    v_perm_b32 v63, v23, v8, s62
    v_mov_b32 v50, v28
    s_cmp_eq_u32 s85, 0
    s_cbranch_scc0 L_xfar
    buffer_store_dwordx4 v[60:63], v1, s[48:51], s20 offen
    s_mov_b64 exec, 0xffff
    buffer_store_dwordx4 v[48:51], v1, s[48:51], s21 offen
    s_branch L_xdone
L_xfar:
    buffer_store_dwordx4 v[60:63], v1, s[48:51], s20 offen sc1
    s_mov_b64 exec, 0xffff
    buffer_store_dwordx4 v[48:51], v1, s[48:51], s21 offen sc1
L_xdone:
    s_mov_b64 exec, -1
    s_waitcnt lgkmcnt(3)
    v_mfma_f32_16x16x32_bf16 v[20:23], v[96:99], v[100:103], 0
    s_waitcnt lgkmcnt(0)
    v_mfma_f32_16x16x32_bf16 v[20:23], v[104:107], v[108:111], v[20:23]
    s_waitcnt vmcnt(6)
    s_cbranch_vccnz L_pf53
    s_waitcnt vmcnt(4)
L_pf53:
    s_sub_u32 m0, s10, 24576
    s_mul_i32 s101, s89, 84
    s_add_u32 s101, s101, s13
    buffer_load_dwordx4 v9, s[36:39], s101 offen sc1 lds
    s_add_u32 m0, s10, 0
    s_add_u32 s101, s12, 81920
    buffer_load_dwordx4 v3, s[28:31], s101 offen nt lds
    s_barrier
    ds_read_b64_tr_b16 v[96:97], v5 offset:24576
    v_lshrrev_b32 v12, 2, v16
    v_and_b32 v13, 0x3ff, v7
    ds_read_b64_tr_b16 v[98:99], v5 offset:25088
    v_lshl_add_u32 v2, v12, 15, v13
    v_lshlrev_b32 v27, 3, v12
    ds_read_b128 v[100:103], v6 offset:4096
    v_add_u32 v24, s32, v1
    v_and_b32 v13, 3, v0
    ds_read_b64_tr_b16 v[104:105], v5 offset:28672
    v_lshlrev_b32 v13, 8, v13
    v_lshl_add_u32 v13, v12, 12, v13
    ds_read_b64_tr_b16 v[106:107], v5 offset:29184
    s_lshl_b32 s60, s53, 2
    v_xor_b32 v14, v17, v16
    ds_read_b128 v[108:111], v6 offset:6144
    v_xor_b32 v15, s60, v14
    v_lshl_add_u32 v13, v15, 4, v13
    s_waitcnt lgkmcnt(3)
    v_mfma_f32_16x16x32_bf16 v[20:23], v[96:99], v[100:103], v[20:23]
    v_add_u32 v25, s33, v13
    v_lshlrev_b32 v13, 8, v17
    s_waitcnt lgkmcnt(0)
    v_mfma_f32_16x16x32_bf16 v[20:23], v[104:107], v[108:111], v[20:23]
    v_lshl_add_u32 v13, v14, 4, v13
    v_add_u32 v24, s32, v13
    v_xor_b32 v29, 64, v24
    v_xor_b32 v30, 128, v24
    v_xor_b32 v31, 192, v24
    v_lshlrev_b32 v26, 11, v17
    v_lshl_add_u32 v26, v16, 3, v26
    v_mov_b32 v64, -1
    v_mov_b32 v68, -1
    v_mov_b32 v72, -1
    v_mov_b32 v76, -1
    v_mov_b32 v80, -1
    v_mov_b32 v84, -1
    v_mov_b32 v88, -1
    v_mov_b32 v92, -1
    s_waitcnt vmcnt(6)
    s_cbranch_vccnz L_pf54
    s_waitcnt vmcnt(5)
L_pf54:
    s_add_u32 m0, s10, 8192
    s_add_u32 s101, s12, 98304
    buffer_load_dwordx4 v3, s[28:31], s101 offen nt lds
    s_barrier
    ds_read_b64_tr_b16 v[96:97], v5 offset:32768
    ds_read_b64_tr_b16 v[98:99], v5 offset:33280
    ds_read_b128 v[100:103], v6 offset:8192
    ds_read_b64_tr_b16 v[104:105], v5 offset:36864
    ds_read_b64_tr_b16 v[106:107], v5 offset:37376
    ds_read_b128 v[108:111], v6 offset:10240
    ds_read_b64_tr_b16 v[224:225], v120 offset:32768
    ds_read_b64_tr_b16 v[228:229], v121 offset:32768
    ds_read_b64_tr_b16 v[232:233], v122 offset:32768
    ds_read_b64_tr_b16 v[236:237], v123 offset:32768
    s_waitcnt lgkmcnt(7)
    v_mfma_f32_16x16x32_bf16 v[20:23], v[96:99], v[100:103], v[20:23]
    s_waitcnt lgkmcnt(4)
    v_mfma_f32_16x16x32_bf16 v[20:23], v[104:107], v[108:111], v[20:23]
    s_waitcnt vmcnt(6)
    s_cbranch_vccnz L_pf55
    s_waitcnt vmcnt(5)
L_pf55:
    s_add_u32 m0, s10, 16384
    s_add_u32 s101, s12, 114688
    buffer_load_dwordx4 v3, s[28:31], s101 offen nt lds
    s_waitcnt lgkmcnt(0)
    s_barrier
    ds_read_b64_tr_b16 v[96:97], v5 offset:40960
    ds_read_b64_tr_b16 v[98:99], v5 offset:41472
    ds_read_b128 v[100:103], v6 offset:12288
    ds_read_b64_tr_b16 v[104:105], v5 offset:45056
    ds_read_b64_tr_b16 v[106:107], v5 offset:45568
    ds_read_b128 v[108:111], v6 offset:14336
    s_waitcnt lgkmcnt(3)
    v_mfma_f32_16x16x32_bf16 v[20:23], v[96:99], v[100:103], v[20:23]
    s_waitcnt lgkmcnt(0)
    v_mfma_f32_16x16x32_bf16 v[20:23], v[104:107], v[108:111], v[20:23]
    s_waitcnt vmcnt(6)
    s_cbranch_vccnz L_pf56
    s_waitcnt vmcnt(2)
L_pf56:
    s_sub_u32 m0, s10, 16384
    s_mul_i32 s101, s89, 88
    s_add_u32 s101, s101, s13
    buffer_load_dwordx4 v9, s[36:39], s101 offen sc1 lds
    s_add_u32 m0, s10, 24576
    s_add_u32 s101, s12, 131072
    buffer_load_dwordx4 v3, s[28:31], s101 offen nt lds
    s_barrier
    ds_read_b64_tr_b16 v[96:97], v5 offset:49152
    ds_read_b64_tr_b16 v[98:99], v5 offset:49664
    ds_read_b128 v[100:103], v6 offset:16384
    ds_read_b64_tr_b16 v[104:105], v5 offset:53248
    ds_read_b64_tr_b16 v[106:107], v5 offset:53760
    ds_read_b128 v[108:111], v6 offset:18432
    v_mul_f32 v20, v20, v124
    v_mul_f32 v21, v21, v124
    v_mul_f32 v22, v22, v124
    v_mul_f32 v23, v23, v124
    s_waitcnt lgkmcnt(3)
    s_nop 0
    v_mfma_f32_16x16x32_bf16 v[20:23], v[96:99], v[100:103], v[20:23]
    s_waitcnt lgkmcnt(0)
    v_mfma_f32_16x16x32_bf16 v[20:23], v[104:107], v[108:111], v[20:23]
    s_waitcnt vmcnt(4)
    s_cbranch_vccnz L_pf57
    s_waitcnt vmcnt(3)
L_pf57:
    s_add_u32 m0, s10, 32768
    s_add_u32 s101, s12, 147456
    buffer_load_dwordx4 v3, s[28:31], s101 offen nt lds
    s_barrier
    ds_read_b64_tr_b16 v[96:97], v5 offset:0
    ds_read_b64_tr_b16 v[98:99], v5 offset:512
    ds_read_b128 v[100:103], v6 offset:20480
    ds_read_b64_tr_b16 v[104:105], v5 offset:4096
    ds_read_b64_tr_b16 v[106:107], v5 offset:4608
    ds_read_b128 v[108:111], v6 offset:22528
    ds_read_b64_tr_b16 v[226:227], v120 offset:40960
    ds_read_b64_tr_b16 v[230:231], v121 offset:40960
    ds_read_b64_tr_b16 v[234:235], v122 offset:40960
    ds_read_b64_tr_b16 v[238:239], v123 offset:40960
    s_waitcnt lgkmcnt(7)
    v_mfma_f32_16x16x32_bf16 v[20:23], v[96:99], v[100:103], v[20:23]
    s_waitcnt lgkmcnt(4)
    v_mfma_f32_16x16x32_bf16 v[20:23], v[104:107], v[108:111], v[20:23]
    s_waitcnt vmcnt(4)
    s_cbranch_vccnz L_pf58
    s_waitcnt vmcnt(3)
L_pf58:
    s_add_u32 m0, s10, 40960
    s_add_u32 s101, s12, 163840
    buffer_load_dwordx4 v3, s[28:31], s101 offen nt lds
    s_waitcnt lgkmcnt(0)
    s_barrier
    ds_read_b64_tr_b16 v[96:97], v5 offset:8192
    ds_read_b64_tr_b16 v[98:99], v5 offset:8704
    ds_read_b128 v[100:103], v6 offset:24576
    ds_read_b64_tr_b16 v[104:105], v5 offset:12288
    ds_read_b64_tr_b16 v[106:107], v5 offset:12800
    ds_read_b128 v[108:111], v6 offset:26624
    s_waitcnt lgkmcnt(3)
    v_mfma_f32_16x16x32_bf16 v[20:23], v[96:99], v[100:103], v[20:23]
    s_waitcnt lgkmcnt(0)
    v_mfma_f32_16x16x32_bf16 v[20:23], v[104:107], v[108:111], v[20:23]
    s_waitcnt vmcnt(4)
    s_cbranch_vccnz L_pf59
    s_waitcnt vmcnt(2)
L_pf59:
    s_sub_u32 m0, s10, 8192
    s_mul_i32 s101, s89, 92
    s_add_u32 s101, s101, s13
    buffer_load_dwordx4 v9, s[36:39], s101 offen sc1 lds
    buffer_load_dwordx4 v[52:55], v1, s[48:51], s23 offen sc1
    buffer_load_dwordx4 v[60:63], v58, s[48:51], s22 offen sc1
    s_add_u32 m0, s10, 49152
    s_add_u32 s101, s12, 180224
    buffer_load_dwordx4 v3, s[28:31], s101 offen nt lds
    s_barrier
    ds_read_b64_tr_b16 v[96:97], v5 offset:16384
    ds_read_b64_tr_b16 v[98:99], v5 offset:16896
    ds_read_b128 v[100:103], v6 offset:28672
    ds_read_b64_tr_b16 v[104:105], v5 offset:20480
    ds_read_b64_tr_b16 v[106:107], v5 offset:20992
    ds_read_b128 v[108:111], v6 offset:30720
    s_waitcnt lgkmcnt(3)
    v_mfma_f32_16x16x32_bf16 v[20:23], v[96:99], v[100:103], v[20:23]
    s_waitcnt lgkmcnt(0)
    v_mfma_f32_16x16x32_bf16 v[20:23], v[104:107], v[108:111], v[20:23]
    s_waitcnt vmcnt(6)
    s_cbranch_vccnz L_pf60
    s_waitcnt vmcnt(5)
L_pf60:
    s_add_u32 m0, s10, 0
    s_add_u32 s101, s12, 196608
    buffer_load_dwordx4 v3, s[28:31], s101 offen nt lds
    s_barrier
    ds_read_b64_tr_b16 v[96:97], v5 offset:24576
    ds_read_b64_tr_b16 v[98:99], v5 offset:25088
    ds_read_b128 v[100:103], v6 offset:32768
    ds_read_b64_tr_b16 v[104:105], v5 offset:28672
    ds_read_b64_tr_b16 v[106:107], v5 offset:29184
    ds_read_b128 v[108:111], v6 offset:34816
    ds_read_b64_tr_b16 v[240:241], v120 offset:49152
    ds_read_b64_tr_b16 v[244:245], v121 offset:49152
    ds_read_b64_tr_b16 v[248:249], v122 offset:49152
    ds_read_b64_tr_b16 v[252:253], v123 offset:49152
    v_mul_f32 v20, v20, v125
    v_mul_f32 v21, v21, v125
    v_mul_f32 v22, v22, v125
    v_mul_f32 v23, v23, v125
    s_waitcnt lgkmcnt(7)
    s_nop 0
    v_mfma_f32_16x16x32_bf16 v[20:23], v[96:99], v[100:103], v[20:23]
    s_waitcnt lgkmcnt(4)
    v_mfma_f32_16x16x32_bf16 v[20:23], v[104:107], v[108:111], v[20:23]
    s_waitcnt vmcnt(6)
    s_cbranch_vccnz L_pf61
    s_waitcnt vmcnt(5)
L_pf61:
    s_add_u32 m0, s10, 8192
    s_add_u32 s101, s12, 212992
    buffer_load_dwordx4 v3, s[28:31], s101 offen nt lds
    s_waitcnt lgkmcnt(0)
    s_barrier
    ds_read_b64_tr_b16 v[96:97], v5 offset:32768
    ds_read_b64_tr_b16 v[98:99], v5 offset:33280
    ds_read_b128 v[100:103], v6 offset:36864
    ds_read_b64_tr_b16 v[104:105], v5 offset:36864
    ds_read_b64_tr_b16 v[106:107], v5 offset:37376
    ds_read_b128 v[108:111], v6 offset:38912
    s_waitcnt lgkmcnt(3)
    v_mfma_f32_16x16x32_bf16 v[20:23], v[96:99], v[100:103], v[20:23]
    s_waitcnt lgkmcnt(0)
    v_mfma_f32_16x16x32_bf16 v[20:23], v[104:107], v[108:111], v[20:23]
    s_waitcnt vmcnt(6)
    s_cbranch_vccnz L_pf62
    s_waitcnt vmcnt(2)
L_pf62:
    s_add_u32 m0, s10, 16384
    s_add_u32 s101, s12, 229376
    buffer_load_dwordx4 v3, s[28:31], s101 offen nt lds
    s_barrier
    ds_read_b64_tr_b16 v[96:97], v5 offset:40960
    ds_read_b64_tr_b16 v[98:99], v5 offset:41472
    ds_read_b128 v[100:103], v6 offset:40960
    ds_read_b64_tr_b16 v[104:105], v5 offset:45056
    ds_read_b64_tr_b16 v[106:107], v5 offset:45568
    ds_read_b128 v[108:111], v6 offset:43008
    s_waitcnt lgkmcnt(3)
    v_mfma_f32_16x16x32_bf16 v[20:23], v[96:99], v[100:103], v[20:23]
    s_waitcnt lgkmcnt(0)
    v_mfma_f32_16x16x32_bf16 v[20:23], v[104:107], v[108:111], v[20:23]
    s_waitcnt vmcnt(3)
    s_cbranch_vccnz L_pf63
    s_waitcnt vmcnt(2)
L_pf63:
    s_add_u32 m0, s10, 24576
    s_add_u32 s101, s12, 245760
    buffer_load_dwordx4 v3, s[28:31], s101 offen nt lds
    s_barrier
    ds_read_b64_tr_b16 v[96:97], v5 offset:49152
    ds_read_b64_tr_b16 v[98:99], v5 offset:49664
    ds_read_b128 v[100:103], v6 offset:45056
    ds_read_b64_tr_b16 v[104:105], v5 offset:53248
    ds_read_b64_tr_b16 v[106:107], v5 offset:53760
    ds_read_b128 v[108:111], v6 offset:47104
    ds_read_b64_tr_b16 v[242:243], v120 offset:57344
    ds_read_b64_tr_b16 v[246:247], v121 offset:57344
    ds_read_b64_tr_b16 v[250:251], v122 offset:57344
    ds_read_b64_tr_b16 v[254:255], v123 offset:57344
    v_perm_b32 v12, v53, v52, s35
    v_perm_b32 v13, v55, v54, s35
    v_lshl_or_b32 v12, v13, 16, v12
    v_cmp_ne_u32 s[94:95], s58, v12
    v_cmp_ne_u32 s[60:61], s58, v61
    s_nop 0
    s_or_b64 s[94:95], s[94:95], s[60:61]
    v_cmp_ne_u32 s[60:61], s58, v63
    s_nop 0
    s_or_b64 s[94:95], s[94:95], s[60:61]
    s_nop 0
    s_cmp_eq_u64 s[94:95], 0
    s_cbranch_scc0 L_spin_x
L_back_x:
    v_max_f32 v12, v18, v60
    v_sub_f32 v13, v18, v12
    v_sub_f32 v14, v60, v12
    v_exp_f32 v13, v13
    v_exp_f32 v14, v14
    v_mul_f32 v12, v28, v13
    v_fma_f32 v12, v62, v14, v12
    v_rcp_f32 v12, v12
    v_and_b32 v52, 0xffffff00, v52
    v_and_b32 v53, 0xffffff00, v53
    v_and_b32 v54, 0xffffff00, v54
    v_and_b32 v55, 0xffffff00, v55
    v_mul_f32 v59, v13, v12
    v_mul_f32 v14, v14, v12
    v_mul_f32 v52, v52, v14
    v_mul_f32 v53, v53, v14
    v_mul_f32 v54, v54, v14
    v_mul_f32 v55, v55, v14
    s_waitcnt lgkmcnt(7)
    v_mfma_f32_16x16x32_bf16 v[20:23], v[96:99], v[100:103], v[20:23]
    s_waitcnt lgkmcnt(4)
    v_mfma_f32_16x16x32_bf16 v[20:23], v[104:107], v[108:111], v[20:23]
    ds_read_b128 v[100:103], v6 offset:49152
    ds_read_b128 v[108:111], v6 offset:51200
    s_waitcnt vmcnt(3)
    s_barrier
    ds_read_b64_tr_b16 v[96:97], v5 offset:0
    ds_read_b64_tr_b16 v[98:99], v5 offset:512
    ds_read_b64_tr_b16 v[104:105], v5 offset:4096
    ds_read_b64_tr_b16 v[106:107], v5 offset:4608
    v_mul_f32 v20, v20, v126
    v_mul_f32 v21, v21, v126
    v_mul_f32 v22, v22, v126
    v_mul_f32 v23, v23, v126
    s_waitcnt lgkmcnt(2)
    s_nop 0
    v_mfma_f32_16x16x32_bf16 v[20:23], v[96:99], v[100:103], v[20:23]
    s_waitcnt lgkmcnt(0)
    v_mfma_f32_16x16x32_bf16 v[20:23], v[104:107], v[108:111], v[20:23]
    ds_read_b128 v[100:103], v6 offset:53248
    ds_read_b128 v[108:111], v6 offset:55296
    s_waitcnt vmcnt(2)
    s_mov_b64 exec, 1
    buffer_store_dword v49, v1, s[48:51], s5 offen sc1
    s_mov_b64 exec, -1
    s_barrier
    ds_read_b64_tr_b16 v[96:97], v5 offset:8192
    ds_read_b64_tr_b16 v[98:99], v5 offset:8704
    ds_read_b64_tr_b16 v[104:105], v5 offset:12288
    ds_read_b64_tr_b16 v[106:107], v5 offset:12800
    s_waitcnt lgkmcnt(2)
    v_mfma_f32_16x16x32_bf16 v[20:23], v[96:99], v[100:103], v[20:23]
    s_waitcnt lgkmcnt(0)
    v_mfma_f32_16x16x32_bf16 v[20:23], v[104:107], v[108:111], v[20:23]
    ds_read_b128 v[100:103], v6 offset:57344
    ds_read_b128 v[108:111], v6 offset:59392
    s_waitcnt vmcnt(2)
    buffer_load_dwordx2 v[50:51], v27, s[48:51], s6 offen sc1
    s_barrier
    ds_read_b64_tr_b16 v[96:97], v5 offset:16384
    ds_read_b64_tr_b16 v[98:99], v5 offset:16896
    ds_read_b64_tr_b16 v[104:105], v5 offset:20480
    ds_read_b64_tr_b16 v[106:107], v5 offset:20992
    s_waitcnt lgkmcnt(2)
    v_mfma_f32_16x16x32_bf16 v[20:23], v[96:99], v[100:103], v[20:23]
    s_waitcnt lgkmcnt(0)
    v_mfma_f32_16x16x32_bf16 v[20:23], v[104:107], v[108:111], v[20:23]
    ds_read_b128 v[100:103], v6 offset:61440
    ds_read_b128 v[108:111], v6 offset:63488
    s_waitcnt vmcnt(2)
    s_barrier
    ds_read_b64_tr_b16 v[96:97], v5 offset:24576
    ds_read_b64_tr_b16 v[98:99], v5 offset:25088
    ds_read_b64_tr_b16 v[104:105], v5 offset:28672
    ds_read_b64_tr_b16 v[106:107], v5 offset:29184
    s_waitcnt lgkmcnt(2)
    v_mfma_f32_16x16x32_bf16 v[20:23], v[96:99], v[100:103], v[20:23]
    s_waitcnt lgkmcnt(0)
    v_mfma_f32_16x16x32_bf16 v[20:23], v[104:107], v[108:111], v[20:23]
    s_nop 7
    v_fma_f32 v52, v20, v59, v52
    v_fma_f32 v53, v21, v59, v53
    v_fma_f32 v54, v22, v59, v54
    v_fma_f32 v55, v23, v59, v55
    v_cvt_pk_bf16_f32 v12, v52, v53
    v_cvt_pk_bf16_f32 v13, v54, v55
    v_cvt_pk_bf16_f32 v14, v52, v53
    v_cvt_pk_bf16_f32 v15, v54, v55
    s_nop 0
    v_permlane16_swap_b32 v12, v14
    v_permlane16_swap_b32 v13, v15
    s_mov_b64 exec, s[0:1]
    buffer_store_dwordx4 v[12:15], v10, s[48:51], s99 offen sc1
    s_mov_b64 exec, -1
    s_barrier
    s_waitcnt vmcnt(1) lgkmcnt(0)
    s_mov_b32 s63, 1048576
    s_mov_b32 s88, 0
L_og:
    v_cmp_eq_u32 s[8:9], s58, v50
    v_cmp_eq_u32 s[10:11], s58, v51
    s_bitcmp1_b32 s88, 0
    s_cbranch_scc1 L_ogs0
    v_max3_u32 v12, v64, v66, v68
    v_max3_u32 v13, v70, v80, v82
    v_max3_u32 v12, v12, v84, v86
    v_max_u32 v12, v12, v13
    v_cmp_eq_u32 vcc, -1, v12
    s_cmp_eq_u32 s63, 0
    s_cbranch_scc1 L_ogm0
    s_cmp_eq_u64 vcc, 0
    s_cbranch_scc1 L_ogm0
    s_and_b64 exec, vcc, s[8:9]
    s_cbranch_scc0 L_ogn0
    buffer_load_dwordx4 v[64:67], v2, s[48:51], s98 offen offset:0 sc1
    buffer_load_dwordx4 v[68:71], v2, s[48:51], s98 offen offset:256 sc1
    buffer_load_dwordx4 v[80:83], v2, s[48:51], s98 offen offset:512 sc1
    buffer_load_dwordx4 v[84:87], v2, s[48:51], s98 offen offset:768 sc1
L_ogn0:
    s_mov_b64 exec, -1
    s_branch L_ogs0
L_ogm0:
    v_mfma_f32_16x16x32_bf16 v[32:35], v[128:131], v[64:67], 0
    v_mfma_f32_16x16x32_bf16 v[36:39], v[132:135], v[64:67], 0
    v_mfma_f32_16x16x32_bf16 v[40:43], v[136:139], v[64:67], 0
    v_mfma_f32_16x16x32_bf16 v[44:47], v[140:143], v[64:67], 0
    v_mfma_f32_16x16x32_bf16 v[32:35], v[144:147], v[68:71], v[32:35]
    v_mfma_f32_16x16x32_bf16 v[36:39], v[148:151], v[68:71], v[36:39]
    v_mfma_f32_16x16x32_bf16 v[40:43], v[152:155], v[68:71], v[40:43]
    v_mfma_f32_16x16x32_bf16 v[44:47], v[156:159], v[68:71], v[44:47]
    v_mfma_f32_16x16x32_bf16 v[32:35], v[192:195], v[80:83], v[32:35]
    v_mfma_f32_16x16x32_bf16 v[36:39], v[196:199], v[80:83], v[36:39]
    v_mfma_f32_16x16x32_bf16 v[40:43], v[200:203], v[80:83], v[40:43]
    v_mfma_f32_16x16x32_bf16 v[44:47], v[204:207], v[80:83], v[44:47]
    v_mfma_f32_16x16x32_bf16 v[32:35], v[208:211], v[84:87], v[32:35]
    v_mfma_f32_16x16x32_bf16 v[36:39], v[212:215], v[84:87], v[36:39]
    v_mfma_f32_16x16x32_bf16 v[40:43], v[216:219], v[84:87], v[40:43]
    v_mfma_f32_16x16x32_bf16 v[44:47], v[220:223], v[84:87], v[44:47]
    s_or_b32 s88, s88, 15
L_ogs0:
    s_bitcmp1_b32 s88, 4
    s_cbranch_scc1 L_ogs1
    v_max3_u32 v12, v72, v74, v76
    v_max3_u32 v13, v78, v88, v90
    v_max3_u32 v12, v12, v92, v94
    v_max_u32 v12, v12, v13
    v_cmp_eq_u32 vcc, -1, v12
    s_cmp_eq_u32 s63, 0
    s_cbranch_scc1 L_ogm1
    s_cmp_eq_u64 vcc, 0
    s_cbranch_scc1 L_ogm1
    s_and_b64 exec, vcc, s[10:11]
    s_cbranch_scc0 L_ogn1
    buffer_load_dwordx4 v[72:75], v2, s[48:51], s98 offen offset:2048 sc1
    buffer_load_dwordx4 v[76:79], v2, s[48:51], s98 offen offset:2304 sc1
    buffer_load_dwordx4 v[88:91], v2, s[48:51], s98 offen offset:2560 sc1
    buffer_load_dwordx4 v[92:95], v2, s[48:51], s98 offen offset:2816 sc1
L_ogn1:
    s_mov_b64 exec, -1
    s_branch L_ogs1
L_ogm1:
    v_mfma_f32_16x16x32_bf16 v[96:99], v[160:163], v[72:75], 0
    v_mfma_f32_16x16x32_bf16 v[100:103], v[164:167], v[72:75], 0
    v_mfma_f32_16x16x32_bf16 v[104:107], v[168:171], v[72:75], 0
    v_mfma_f32_16x16x32_bf16 v[108:111], v[172:175], v[72:75], 0
    v_mfma_f32_16x16x32_bf16 v[96:99], v[176:179], v[76:79], v[96:99]
    v_mfma_f32_16x16x32_bf16 v[100:103], v[180:183], v[76:79], v[100:103]
    v_mfma_f32_16x16x32_bf16 v[104:107], v[184:187], v[76:79], v[104:107]
    v_mfma_f32_16x16x32_bf16 v[108:111], v[188:191], v[76:79], v[108:111]
    v_mfma_f32_16x16x32_bf16 v[96:99], v[224:227], v[88:91], v[96:99]
    v_mfma_f32_16x16x32_bf16 v[100:103], v[228:231], v[88:91], v[100:103]
    v_mfma_f32_16x16x32_bf16 v[104:107], v[232:235], v[88:91], v[104:107]
    v_mfma_f32_16x16x32_bf16 v[108:111], v[236:239], v[88:91], v[108:111]
    v_mfma_f32_16x16x32_bf16 v[96:99], v[240:243], v[92:95], v[96:99]
    v_mfma_f32_16x16x32_bf16 v[100:103], v[244:247], v[92:95], v[100:103]
    v_mfma_f32_16x16x32_bf16 v[104:107], v[248:251], v[92:95], v[104:107]
    v_mfma_f32_16x16x32_bf16 v[108:111], v[252:255], v[92:95], v[108:111]
    s_or_b32 s88, s88, 240
L_ogs1:
    s_cmp_eq_u32 s88, 0xff
    s_cbranch_scc1 L_ogd
    s_and_b64 s[60:61], s[8:9], s[10:11]
    s_cmp_eq_u64 s[60:61], -1
    s_cbranch_scc1 L_oh
    buffer_load_dwordx2 v[50:51], v27, s[48:51], s6 offen sc1
L_oh:
    s_sub_u32 s63, s63, 1
    s_waitcnt vmcnt(0)
    s_branch L_og
L_ogd:
    s_nop 7
    v_add_f32 v32, v32, v96
    v_add_f32 v33, v33, v97
    v_add_f32 v34, v34, v98
    v_add_f32 v35, v35, v99
    ds_write_b128 v24, v[32:35] offset:0
    v_add_f32 v36, v36, v100
    v_add_f32 v37, v37, v101
    v_add_f32 v38, v38, v102
    v_add_f32 v39, v39, v103
    ds_write_b128 v29, v[36:39] offset:4096
    v_add_f32 v40, v40, v104
    v_add_f32 v41, v41, v105
    v_add_f32 v42, v42, v106
    v_add_f32 v43, v43, v107
    ds_write_b128 v30, v[40:43] offset:8192
    v_add_f32 v44, v44, v108
    v_add_f32 v45, v45, v109
    v_add_f32 v46, v46, v110
    v_add_f32 v47, v47, v111
    ds_write_b128 v31, v[44:47] offset:12288
    s_waitcnt lgkmcnt(0)
    s_barrier
    ds_read_b128 v[64:67], v25 offset:0
    ds_read_b128 v[68:71], v25 offset:1024
    ds_read_b128 v[72:75], v25 offset:2048
    ds_read_b128 v[76:79], v25 offset:3072
    s_cmp_eq_u32 s53, s46
    s_cbranch_scc1 L_own
    s_waitcnt lgkmcnt(2)
    v_add_f32 v64, v64, v68
    v_add_f32 v65, v65, v69
    v_add_f32 v66, v66, v70
    v_add_f32 v67, v67, v71
    s_waitcnt lgkmcnt(0)
    v_add_f32 v72, v72, v76
    v_add_f32 v73, v73, v77
    v_add_f32 v74, v74, v78
    v_add_f32 v75, v75, v79
    v_add_f32 v64, v64, v72
    v_add_f32 v65, v65, v73
    v_add_f32 v66, v66, v74
    v_add_f32 v67, v67, v75
    v_perm_b32 v80, v64, v8, s34
    s_add_u32 s62, s34, 1
    v_perm_b32 v81, v65, v8, s62
    s_add_u32 s62, s34, 2
    v_perm_b32 v82, v66, v8, s62
    s_add_u32 s62, s34, 3
    v_perm_b32 v83, v67, v8, s62
    buffer_store_dwordx4 v[80:83], v1, s[48:51], s3 offen sc1
    s_branch L_fin
L_own:
    buffer_load_dwordx4 v[96:99], v1, s[48:51], s92 offen sc1
    buffer_load_dwordx4 v[100:103], v1, s[48:51], s93 offen sc1
    buffer_load_dwordx4 v[104:107], v1, s[48:51], s96 offen sc1
    s_waitcnt lgkmcnt(0)
    v_add_f32 v64, v64, v68
    v_add_f32 v65, v65, v69
    v_add_f32 v66, v66, v70
    v_add_f32 v67, v67, v71
    v_add_f32 v72, v72, v76
    v_add_f32 v73, v73, v77
    v_add_f32 v74, v74, v78
    v_add_f32 v75, v75, v79
    v_add_f32 v64, v64, v72
    v_add_f32 v65, v65, v73
    v_add_f32 v66, v66, v74
    v_add_f32 v67, v67, v75
    s_mov_b32 s63, 1048576
L_h:
    s_waitcnt vmcnt(0)
    v_perm_b32 v80, v97, v96, s35
    v_perm_b32 v84, v99, v98, s35
    v_lshl_or_b32 v80, v84, 16, v80
    v_perm_b32 v81, v101, v100, s35
    v_perm_b32 v85, v103, v102, s35
    v_lshl_or_b32 v81, v85, 16, v81
    v_perm_b32 v82, v105, v104, s35
    v_perm_b32 v86, v107, v106, s35
    v_lshl_or_b32 v82, v86, 16, v82
    v_cmp_ne_u32 s[8:9], s58, v80
    v_cmp_ne_u32 s[10:11], s58, v81
    v_cmp_ne_u32 s[12:13], s58, v82
    s_nop 0
    s_or_b64 vcc, s[8:9], s[10:11]
    s_or_b64 vcc, vcc, s[12:13]
    s_cbranch_scc0 L_hd
    s_sub_u32 s63, s63, 1
    s_cbranch_scc1 L_hd
    s_cmp_eq_u64 s[8:9], 0
    s_cbranch_scc1 L_hs0
    buffer_load_dwordx4 v[96:99], v1, s[48:51], s92 offen sc1
L_hs0:
    s_cmp_eq_u64 s[10:11], 0
    s_cbranch_scc1 L_hs1
    buffer_load_dwordx4 v[100:103], v1, s[48:51], s93 offen sc1
L_hs1:
    s_cmp_eq_u64 s[12:13], 0
    s_cbranch_scc1 L_hs2
    buffer_load_dwordx4 v[104:107], v1, s[48:51], s96 offen sc1
L_hs2:
    s_branch L_h
L_hd:
    v_and_b32 v96, 0xffffff00, v96
    v_and_b32 v97, 0xffffff00, v97
    v_and_b32 v98, 0xffffff00, v98
    v_and_b32 v99, 0xffffff00, v99
    v_and_b32 v100, 0xffffff00, v100
    v_and_b32 v101, 0xffffff00, v101
    v_and_b32 v102, 0xffffff00, v102
    v_and_b32 v103, 0xffffff00, v103
    v_and_b32 v104, 0xffffff00, v104
    v_and_b32 v105, 0xffffff00, v105
    v_and_b32 v106, 0xffffff00, v106
    v_and_b32 v107, 0xffffff00, v107
    v_add_f32 v64, v64, v96
    v_add_f32 v65, v65, v97
    v_add_f32 v66, v66, v98
    v_add_f32 v67, v67, v99
    v_add_f32 v100, v100, v104
    v_add_f32 v101, v101, v105
    v_add_f32 v102, v102, v106
    v_add_f32 v103, v103, v107
    v_add_f32 v64, v64, v100
    v_add_f32 v65, v65, v101
    v_add_f32 v66, v66, v102
    v_add_f32 v67, v67, v103
    v_cvt_pk_bf16_f32 v14, v64, v65
    v_cvt_pk_bf16_f32 v15, v66, v67
    buffer_store_dwordx2 v[14:15], v26, s[40:43], s2 offen nt
L_fin:
L_end:
    s_endpgm
L_spin_q:
    s_mov_b32 s63, 1048576
L_spin2_q:
    s_sleep 1
    buffer_load_dword v112, v113, s[48:51], s97 offen offset:1024 sc1
    s_waitcnt vmcnt(0)
    v_cmp_ne_u32 s[94:95], s58, v112
    s_nop 0
    s_cmp_eq_u64 s[94:95], 0
    s_cbranch_scc1 L_back_q
    s_sub_u32 s63, s63, 1
    s_cbranch_scc0 L_spin2_q
    s_branch L_back_q
L_spin_a:
    s_mov_b32 s63, 1048576
L_spin2_a:
    s_sleep 1
    buffer_load_dwordx4 v[92:95], v1, s[48:51], 0 offen offset:1024 sc1
    s_waitcnt vmcnt(0)
    v_cmp_ne_u32 s[94:95], s58, v92
    v_cmp_ne_u32 s[60:61], s58, v93
    s_nop 0
    s_or_b64 s[94:95], s[94:95], s[60:61]
    v_cmp_ne_u32 s[60:61], s58, v94
    s_nop 0
    s_or_b64 s[94:95], s[94:95], s[60:61]
    v_cmp_ne_u32 s[60:61], s58, v95
    s_nop 0
    s_or_b64 s[94:95], s[94:95], s[60:61]
    s_nop 0
    s_cmp_eq_u64 s[94:95], 0
    s_cbranch_scc1 L_back_a
    s_sub_u32 s63, s63, 1
    s_cbranch_scc0 L_spin2_a
    s_branch L_back_a
L_spin_x:
    s_mov_b32 s63, 1048576
L_spin2_x:
    buffer_load_dwordx4 v[52:55], v1, s[48:51], s23 offen sc1
    buffer_load_dwordx4 v[60:63], v58, s[48:51], s22 offen sc1
    s_waitcnt vmcnt(0)
    v_perm_b32 v12, v53, v52, s35
    v_perm_b32 v13, v55, v54, s35
    v_lshl_or_b32 v12, v13, 16, v12
    v_cmp_ne_u32 s[94:95], s58, v12
    v_cmp_ne_u32 s[60:61], s58, v61
    s_nop 0
    s_or_b64 s[94:95], s[94:95], s[60:61]
    v_cmp_ne_u32 s[60:61], s58, v63
    s_nop 0
    s_or_b64 s[94:95], s[94:95], s[60:61]
    s_nop 0
    s_cmp_eq_u64 s[94:95], 0
    s_cbranch_scc1 L_back_x
    s_sub_u32 s63, s63, 1
    s_cbranch_scc0 L_spin2_x
    s_branch L_back_x
L_code_end:
.section .rodata,"a"
.p2align 6
.amdhsa_kernel standalone__gqa_block_cached__sampling_kernel
  .amdhsa_next_free_vgpr 256
  .amdhsa_next_free_sgpr 102
  .amdhsa_accum_offset 256
  .amdhsa_group_segment_fixed_size 0
  .amdhsa_kernarg_size 64
  .amdhsa_user_sgpr_count 2
  .amdhsa_user_sgpr_kernarg_segment_ptr 1
  .amdhsa_system_sgpr_workgroup_id_x 1
  .amdhsa_float_denorm_mode_32 3
  .amdhsa_float_denorm_mode_16_64 3
.end_amdhsa_kernel
```
